```python
import torch

def _softmax(x, axis=-1):
    return torch.softmax(x, dim=axis)
def _gelu(x):
    return torch.nn.functional.gelu(x, approximate="tanh")
def _silu(x):
    return torch.nn.functional.silu(x)
def _sigmoid(x):
    return torch.sigmoid(x)
def _layernorm(x, axis=-1, eps=1e-5):
    m = x.mean(dim=axis, keepdim=True)
    v = x.var(dim=axis, keepdim=True, unbiased=False)
    return (x - m) / torch.sqrt(v + eps)
def _scatter_add(tgt, idx, src, axis=0):
    return tgt.clone().index_add_(axis, idx, src)
def _segment_sum(src, seg, n):
    out = torch.zeros((n,) + src.shape[1:], dtype=src.dtype)
    return out.index_add_(0, seg, src)
def _pad(x, pw):
    flat = tuple(v for pair in reversed(pw) for v in pair)
    return torch.nn.functional.pad(x, flat)

kernel_name = 'sequential_preLN__sliding_block__moe_arch_mod__prompt'

def setup_inputs():

    _w = (lambda a: (lambda t: t.to(torch.bfloat16) if t.is_floating_point() else t)(torch.as_tensor(a)))
    def _A_setup():
        B, S, D = 1, 2048, 1024
        return {
            "x": _w((lambda *s: torch.randn(*s, dtype=torch.bfloat16) * 0.05)(B, S, D)),
            "wqkv": _w((lambda *s: torch.randn(*s, dtype=torch.bfloat16) * 0.05)(D, 3 * D)),
            "wo": _w((lambda *s: torch.randn(*s, dtype=torch.bfloat16) * 0.05)(D, D)),
        }
    _A_in = _A_setup()

    def _B_setup():
        B, S, D, F, C = 1, 2048, 1024, 3584, 2
        return {
            "x": _w((lambda *s: torch.randn(*s, dtype=torch.bfloat16) * 0.05)(B, S, D)),
            "w_r": _w((lambda *s: torch.randn(*s, dtype=torch.bfloat16) * 0.05)(D)),
            "w_gate": _w((lambda *s: torch.randn(*s, dtype=torch.bfloat16) * 0.05)(D, F)),
            "w_up": _w((lambda *s: torch.randn(*s, dtype=torch.bfloat16) * 0.05)(D, F)),
            "w_down": _w((lambda *s: torch.randn(*s, dtype=torch.bfloat16) * 0.05)(F, D)),
        }
    _B_in = _B_setup()

    return {
        "A_x": _A_in["x"],
        "A_wqkv": _A_in["wqkv"],
        "A_wo": _A_in["wo"],
        "B_x": _B_in["x"],
        "B_w_r": _B_in["w_r"],
        "B_w_gate": _B_in["w_gate"],
        "B_w_up": _B_in["w_up"],
        "B_w_down": _B_in["w_down"],
    }

def reference(A_x, A_wqkv, A_wo, B_x, B_w_r, B_w_gate, B_w_up, B_w_down):
    def _A_ref(x, wqkv, wo):
        B, S, D = x.shape
        H = 32; Dh = D // H; W = 256
        qkv = (lambda x, *d: x.permute(*d))((x @ wqkv).reshape(B, S, 3, H, Dh), 2, 0, 3, 1, 4)
        q, k, v = qkv[0], qkv[1], qkv[2]
        scores = torch.einsum("bhqd,bhkd->bhqk", q, k) * (Dh ** -0.5)
        idx = torch.arange(S)
        mask = (idx[:, None] - idx[None, :] >= 0) & (idx[:, None] - idx[None, :] < W)
        scores = torch.where(mask[None, None], scores, -1e9)
        p = _softmax(scores, axis=-1)
        o = torch.einsum("bhqk,bhkd->bhqd", p, v)
        return (lambda x, *d: x.permute(*d))(o, 0, 2, 1, 3).reshape(B, S, D) @ wo

    def _B_ref(x, w_r, w_gate, w_up, w_down):
        B, S, D = x.shape
        C = 2
        r = x @ w_r
        idx = torch.argsort(-r, axis=-1)[:, :C]
        idx_e = (lambda x, n, axis: torch.repeat_interleave(x, n, dim=axis))(idx.reshape(B, C, 1), D, axis=2)
        x_sel = (lambda x, i, axis: torch.take_along_dim(x, i, dim=axis))(x, idx_e, axis=1)
        g = _silu(x_sel @ w_gate)
        u = x_sel @ w_up
        y = (g * u) @ w_down
        r_sel = _sigmoid((lambda x, i, axis: torch.take_along_dim(x, i, dim=axis))(r, idx, axis=1))
        y = y * r_sel.reshape(B, C, 1)
        b_off = (torch.arange(B) * S).reshape(B, 1)
        flat_idx = (idx + b_off).reshape(B * C)
        zero = (x * 0.0).reshape(B * S, D)
        upd = _scatter_add(zero, flat_idx, y.reshape(B * C, D), axis=0)
        return x + upd.reshape(B, S, D)

    x = A_x
    h = x + _A_ref(_layernorm(x, axis=-1), A_wqkv, A_wo)
    h2 = h + _B_ref(_layernorm(h, axis=-1), B_w_r, B_w_gate, B_w_up, B_w_down)
    return h2
```

```asm
; @launch grid=(256,1,1) block=(512,1,1) lds=163840
.amdgcn_target "amdgcn-amd-amdhsa--gfx950"
.text
.globl sequential_preLN__sliding_block__moe_arch_mod__prompt_kernel
.p2align 8
.type sequential_preLN__sliding_block__moe_arch_mod__prompt_kernel,@function
sequential_preLN__sliding_block__moe_arch_mod__prompt_kernel:
s_cmp_ge_u32 s2, 256
s_cbranch_scc1 L_exit
s_load_dwordx16 s[4:19], s[0:1], 0
s_load_dwordx4 s[20:23], s[0:1], 64
s_load_dwordx2 s[24:25], s[0:1], 80
v_and_b32 v1, 63, v0
v_lshrrev_b32 v2, 6, v0
s_mov_b32 s78, s2
v_readfirstlane_b32 s72, v2
s_and_b32 s80, s2, 7
s_lshr_b32 s81, s2, 3
s_lshr_b32 s82, s80, 2
s_lshl_b32 s82, s82, 3
s_lshr_b32 s83, s81, 2
s_add_u32 s73, s82, s83
s_and_b32 s82, s80, 3
s_lshl_b32 s82, s82, 2
s_and_b32 s83, s81, 3
s_add_u32 s74, s82, s83
s_lshl_b32 s82, s80, 1
s_lshr_b32 s83, s81, 4
s_add_u32 s75, s82, s83
s_and_b32 s76, s81, 15
s_mul_i32 s82, s80, 28
s_add_u32 s82, s82, s81
s_cmp_lt_u32 s81, 28
s_cselect_b32 s79, s82, 0xffff
s_waitcnt lgkmcnt(0)
s_mov_b32 s36, s4
s_mov_b32 s37, s5
s_mov_b32 s38, 4194304
s_mov_b32 s39, 0x00020000
s_mov_b32 s68, s6
s_mov_b32 s69, s7
s_mov_b32 s70, 6291456
s_mov_b32 s71, 0x00020000
s_mov_b32 s44, s24
s_mov_b32 s45, s25
s_mov_b32 s46, 268435456
s_mov_b32 s47, 0x00020000
v_mov_b32 v2, 16384000
buffer_load_dword v3, v2, s[44:47], 0 offen sc1
s_cmp_ge_u32 s72, 4
s_cbranch_scc1 L_p1_helper
s_setprio 1
s_lshr_b32 s82, s72, 1
s_and_b32 s83, s72, 1
s_lshl_b32 s84, s73, 7
s_lshl_b32 s85, s74, 3
s_add_u32 s84, s84, s85
s_lshl_b32 s85, s72, 1
s_add_u32 s92, s84, s85
s_lshl_b32 s84, s92, 11
v_lshrrev_b32 v5, 5, v1
v_lshlrev_b32 v5, 11, v5
v_and_b32 v6, 31, v1
v_lshl_add_u32 v5, v6, 4, v5
v_add_u32 v5, s84, v5
buffer_load_dwordx4 v[112:115], v5, s[36:39], 0 offen offset:0
buffer_load_dwordx4 v[116:119], v5, s[36:39], 0 offen offset:512
buffer_load_dwordx4 v[120:123], v5, s[36:39], 0 offen offset:1024
buffer_load_dwordx4 v[124:127], v5, s[36:39], 0 offen offset:1536
v_lshrrev_b32 v10, 3, v1
v_and_b32 v11, 7, v1
s_lshl_b32 s84, s73, 6
s_lshl_b32 s85, s72, 4
s_add_u32 s84, s84, s85
v_add_u32 v5, s84, v10
s_mov_b32 s85, 6144
v_mul_lo_u32 v5, v5, s85
s_lshl_b32 s84, s74, 7
v_lshl_add_u32 v5, v11, 4, v5
v_add_u32 v5, s84, v5
s_mov_b32 s84, 0
buffer_load_dwordx4 v[128:131], v5, s[68:71], s84 offen
s_mov_b32 s84, 49152
buffer_load_dwordx4 v[132:135], v5, s[68:71], s84 offen
s_mov_b32 s84, 2048
buffer_load_dwordx4 v[136:139], v5, s[68:71], s84 offen
s_mov_b32 s84, 51200
buffer_load_dwordx4 v[140:143], v5, s[68:71], s84 offen
s_mov_b32 s84, 4096
buffer_load_dwordx4 v[144:147], v5, s[68:71], s84 offen
s_mov_b32 s84, 53248
buffer_load_dwordx4 v[148:151], v5, s[68:71], s84 offen
s_mov_b32 s40, s8
s_mov_b32 s41, s9
s_mov_b32 s42, 2097152
s_mov_b32 s43, 0x00020000
s_mov_b32 s48, s20
s_mov_b32 s49, s21
s_mov_b32 s50, 4194304
s_mov_b32 s51, 0x00020000
s_mov_b32 s52, s14
s_mov_b32 s53, s15
s_mov_b32 s54, 7340032
s_mov_b32 s55, 0x00020000
s_mov_b32 s56, s16
s_mov_b32 s57, s17
s_mov_b32 s58, 7340032
s_mov_b32 s59, 0x00020000
s_mov_b32 s60, s18
s_mov_b32 s61, s19
s_mov_b32 s62, 7340032
s_mov_b32 s63, 0x00020000
s_mov_b32 s64, s12
s_mov_b32 s65, s13
s_mov_b32 s66, 2048
s_mov_b32 s67, 0x00020000
v_lshrrev_b32 v2, 4, v1
v_and_b32 v4, 15, v1
s_lshl_b32 s84, s82, 8
s_add_u32 s84, s84, 122880
v_lshl_add_u32 v205, v4, 2, s84
v_lshl_add_u32 v208, v2, 4, s84
s_lshl_b32 s85, s83, 7
s_add_u32 s85, s85, 123904
v_lshl_add_u32 v206, v2, 4, s85
v_lshl_add_u32 v207, v4, 2, s85
v_lshrrev_b32 v5, 1, v2
v_lshlrev_b32 v5, 10, v5
v_and_b32 v6, 1, v2
v_lshlrev_b32 v6, 9, v6
v_add_u32 v5, v5, v6
v_lshrrev_b32 v6, 3, v4
v_lshlrev_b32 v6, 8, v6
v_and_b32 v7, 7, v4
v_lshl_add_u32 v6, v7, 4, v6
v_add_u32 v200, v5, v6
v_lshl_add_u32 v201, v4, 4, v5
s_mul_i32 s86, s83, 49152
s_lshl_b32 s87, s82, 13
s_add_u32 s86, s86, s87
s_add_u32 s86, s86, 32768
s_lshl_b32 s87, s73, 4
s_add_u32 s87, s87, s74
s_lshl_b32 s87, s87, 15
s_lshl_b32 s88, s83, 14
s_add_u32 s87, s87, s88
s_lshl_b32 s88, s82, 13
s_add_u32 s87, s87, s88
s_add_u32 s87, s87, 0
v_add_u32 v203, s87, v200
v_add_u32 v204, s87, v201
s_lshl_b32 s88, s83, 13
s_lshl_b32 s89, s82, 12
s_add_u32 s88, s88, s89
s_add_u32 s88, s88, 147456
v_add_u32 v202, s88, v201
v_add_u32 v200, s86, v200
v_add_u32 v201, s86, v201
s_mov_b32 s4, 0xffffffff
s_mov_b32 s5, 0xfffffff0
s_mov_b32 s6, 0xfffffffe
s_mov_b32 s7, 0xffffffe0
s_mov_b32 s8, 0xfffffffc
s_mov_b32 s9, 0xffffffc0
s_mov_b32 s10, 0xfffffff8
s_mov_b32 s11, 0xffffff80
s_mov_b32 s12, 0xffff0000
s_mov_b32 s13, 0xfff00000
s_mov_b32 s14, 0xfffe0000
s_mov_b32 s15, 0xffe00000
s_mov_b32 s16, 0xfffc0000
s_mov_b32 s17, 0xffc00000
s_mov_b32 s18, 0xfff80000
s_mov_b32 s19, 0xff800000
s_mov_b32 s20, 0xffffff00
s_mov_b32 s21, 0xfffff000
s_mov_b32 s22, 0xfffffe00
s_mov_b32 s23, 0xffffe000
s_mov_b32 s24, 0xfffffc00
s_mov_b32 s25, 0xffffc000
s_mov_b32 s26, 0xfffff800
s_mov_b32 s27, 0xffff8000
s_mov_b32 s28, 0xff000000
s_mov_b32 s29, 0xf0000000
s_mov_b32 s30, 0xfe000000
s_mov_b32 s31, 0xe0000000
s_mov_b32 s32, 0xfc000000
s_mov_b32 s33, 0xc0000000
s_mov_b32 s34, 0xf8000000
s_mov_b32 s35, 0x80000000
v_lshrrev_b32 v2, 4, v1
v_and_b32 v4, 15, v1
v_bfe_u32 v5, v4, 1, 3
v_xor_b32 v5, v5, v2
s_lshl_b32 s84, s82, 6
v_add_u32 v6, s84, v4
v_lshlrev_b32 v6, 7, v6
v_xor_b32 v7, 0, v5
v_lshl_add_u32 v192, v7, 4, v6
v_xor_b32 v7, 4, v5
v_lshl_add_u32 v193, v7, 4, v6
v_lshrrev_b32 v7, 2, v4
v_lshl_add_u32 v7, v2, 3, v7
v_and_b32 v8, 3, v4
v_lshlrev_b32 v8, 3, v8
s_lshl_b32 s84, s83, 6
v_add_u32 v8, s84, v8
v_bfe_u32 v9, v4, 3, 1
v_lshlrev_b32 v9, 6, v9
v_xor_b32 v8, v8, v9
v_and_b32 v9, 1, v2
v_lshlrev_b32 v9, 5, v9
v_xor_b32 v8, v8, v9
v_lshl_add_u32 v194, v7, 7, v8
v_add_u32 v194, 16384, v194
v_xor_b32 v195, 32, v194
v_mov_b32 v196, v192
v_mov_b32 v198, v194
v_mov_b32 v197, v193
v_mov_b32 v199, v195
s_mov_b32 s80, 0
s_waitcnt vmcnt(6)
v_readfirstlane_b32 s77, v3
s_nop 1
s_mul_i32 s77, s77, 1664525
s_add_u32 s77, s77, 1013904223
v_lshlrev_b32 v16, 16, v112
v_and_b32 v17, 0xffff0000, v112
v_lshlrev_b32 v18, 16, v113
v_and_b32 v19, 0xffff0000, v113
v_lshlrev_b32 v20, 16, v114
v_and_b32 v21, 0xffff0000, v114
v_lshlrev_b32 v22, 16, v115
v_and_b32 v23, 0xffff0000, v115
v_lshlrev_b32 v24, 16, v116
v_and_b32 v25, 0xffff0000, v116
v_lshlrev_b32 v26, 16, v117
v_and_b32 v27, 0xffff0000, v117
v_lshlrev_b32 v28, 16, v118
v_and_b32 v29, 0xffff0000, v118
v_lshlrev_b32 v30, 16, v119
v_and_b32 v31, 0xffff0000, v119
v_lshlrev_b32 v32, 16, v120
v_and_b32 v33, 0xffff0000, v120
v_lshlrev_b32 v34, 16, v121
v_and_b32 v35, 0xffff0000, v121
v_lshlrev_b32 v36, 16, v122
v_and_b32 v37, 0xffff0000, v122
v_lshlrev_b32 v38, 16, v123
v_and_b32 v39, 0xffff0000, v123
v_lshlrev_b32 v40, 16, v124
v_and_b32 v41, 0xffff0000, v124
v_lshlrev_b32 v42, 16, v125
v_and_b32 v43, 0xffff0000, v125
v_lshlrev_b32 v44, 16, v126
v_and_b32 v45, 0xffff0000, v126
v_lshlrev_b32 v46, 16, v127
v_and_b32 v47, 0xffff0000, v127
v_pk_add_f32 v[152:153], v[16:17], v[18:19]
v_pk_mul_f32 v[154:155], v[16:17], v[16:17]
v_pk_fma_f32 v[154:155], v[18:19], v[18:19], v[154:155]
v_pk_add_f32 v[152:153], v[152:153], v[20:21]
v_pk_fma_f32 v[154:155], v[20:21], v[20:21], v[154:155]
v_pk_add_f32 v[152:153], v[152:153], v[22:23]
v_pk_fma_f32 v[154:155], v[22:23], v[22:23], v[154:155]
v_pk_add_f32 v[152:153], v[152:153], v[24:25]
v_pk_fma_f32 v[154:155], v[24:25], v[24:25], v[154:155]
v_pk_add_f32 v[152:153], v[152:153], v[26:27]
v_pk_fma_f32 v[154:155], v[26:27], v[26:27], v[154:155]
v_pk_add_f32 v[152:153], v[152:153], v[28:29]
v_pk_fma_f32 v[154:155], v[28:29], v[28:29], v[154:155]
v_pk_add_f32 v[152:153], v[152:153], v[30:31]
v_pk_fma_f32 v[154:155], v[30:31], v[30:31], v[154:155]
v_pk_add_f32 v[152:153], v[152:153], v[32:33]
v_pk_fma_f32 v[154:155], v[32:33], v[32:33], v[154:155]
v_pk_add_f32 v[152:153], v[152:153], v[34:35]
v_pk_fma_f32 v[154:155], v[34:35], v[34:35], v[154:155]
v_pk_add_f32 v[152:153], v[152:153], v[36:37]
v_pk_fma_f32 v[154:155], v[36:37], v[36:37], v[154:155]
v_pk_add_f32 v[152:153], v[152:153], v[38:39]
v_pk_fma_f32 v[154:155], v[38:39], v[38:39], v[154:155]
v_pk_add_f32 v[152:153], v[152:153], v[40:41]
v_pk_fma_f32 v[154:155], v[40:41], v[40:41], v[154:155]
v_pk_add_f32 v[152:153], v[152:153], v[42:43]
v_pk_fma_f32 v[154:155], v[42:43], v[42:43], v[154:155]
v_pk_add_f32 v[152:153], v[152:153], v[44:45]
v_pk_fma_f32 v[154:155], v[44:45], v[44:45], v[154:155]
v_pk_add_f32 v[152:153], v[152:153], v[46:47]
v_pk_fma_f32 v[154:155], v[46:47], v[46:47], v[154:155]
v_add_f32 v152, v152, v153
v_add_f32 v153, v154, v155
s_nop 0
v_add_f32_dpp v152, v152, v152 quad_perm:[1,0,3,2] row_mask:0xf bank_mask:0xf
v_add_f32_dpp v153, v153, v153 quad_perm:[1,0,3,2] row_mask:0xf bank_mask:0xf
s_nop 0
v_add_f32_dpp v152, v152, v152 quad_perm:[2,3,0,1] row_mask:0xf bank_mask:0xf
v_add_f32_dpp v153, v153, v153 quad_perm:[2,3,0,1] row_mask:0xf bank_mask:0xf
s_nop 0
v_add_f32_dpp v152, v152, v152 row_half_mirror row_mask:0xf bank_mask:0xf
v_add_f32_dpp v153, v153, v153 row_half_mirror row_mask:0xf bank_mask:0xf
s_nop 0
v_add_f32_dpp v152, v152, v152 row_mirror row_mask:0xf bank_mask:0xf
v_add_f32_dpp v153, v153, v153 row_mirror row_mask:0xf bank_mask:0xf
v_mov_b32 v156, v152
s_nop 1
v_permlane16_swap_b32 v152, v156
v_add_f32 v152, v152, v156
v_mov_b32 v157, v153
s_nop 1
v_permlane16_swap_b32 v153, v157
v_add_f32 v153, v153, v157
s_mov_b32 s88, 0x3a800000
s_mov_b32 s89, 0x3727c5ac
v_mul_f32 v152, s88, v152
v_mul_f32 v153, s88, v153
v_fma_f32 v153, -v152, v152, v153
v_max_f32 v153, 0, v153
v_cvt_pk_bf16_f32 v156, v153, v153
v_lshlrev_b32 v153, 16, v156
v_add_f32 v153, s89, v153
v_cvt_pk_bf16_f32 v156, v153, v153
v_lshlrev_b32 v153, 16, v156
v_sqrt_f32 v153, v153
s_nop 0
v_cvt_pk_bf16_f32 v156, v153, v153
v_lshlrev_b32 v153, 16, v156
v_rcp_f32 v153, v153
v_cvt_pk_bf16_f32 v156, v152, v152
v_lshlrev_b32 v152, 16, v156
v_mov_b32 v154, s77
v_mov_b32 v155, 0
s_lshl_b32 s87, s92, 4
s_add_u32 s87, s87, 12582912
v_lshrrev_b32 v5, 5, v1
v_lshl_add_u32 v5, v5, 4, s87
s_waitcnt vmcnt(0)
v_and_b32 v6, 31, v1
v_cmp_eq_u32 vcc, 0, v6
s_nop 1
s_and_saveexec_b64 s[96:97], vcc
buffer_store_dwordx4 v[152:155], v5, s[44:47], 0 offen sc1
s_mov_b64 exec, s[96:97]
v_lshlrev_b32 v16, 16, v128
v_and_b32 v17, 0xffff0000, v128
v_lshlrev_b32 v18, 16, v129
v_and_b32 v19, 0xffff0000, v129
v_lshlrev_b32 v20, 16, v130
v_and_b32 v21, 0xffff0000, v130
v_lshlrev_b32 v22, 16, v131
v_and_b32 v23, 0xffff0000, v131
v_lshlrev_b32 v24, 16, v132
v_and_b32 v25, 0xffff0000, v132
v_lshlrev_b32 v26, 16, v133
v_and_b32 v27, 0xffff0000, v133
v_lshlrev_b32 v28, 16, v134
v_and_b32 v29, 0xffff0000, v134
v_lshlrev_b32 v30, 16, v135
v_and_b32 v31, 0xffff0000, v135
v_lshlrev_b32 v32, 16, v136
v_and_b32 v33, 0xffff0000, v136
v_lshlrev_b32 v34, 16, v137
v_and_b32 v35, 0xffff0000, v137
v_lshlrev_b32 v36, 16, v138
v_and_b32 v37, 0xffff0000, v138
v_lshlrev_b32 v38, 16, v139
v_and_b32 v39, 0xffff0000, v139
v_lshlrev_b32 v40, 16, v140
v_and_b32 v41, 0xffff0000, v140
v_lshlrev_b32 v42, 16, v141
v_and_b32 v43, 0xffff0000, v141
v_lshlrev_b32 v44, 16, v142
v_and_b32 v45, 0xffff0000, v142
v_lshlrev_b32 v46, 16, v143
v_and_b32 v47, 0xffff0000, v143
v_lshlrev_b32 v48, 16, v144
v_and_b32 v49, 0xffff0000, v144
v_lshlrev_b32 v50, 16, v145
v_and_b32 v51, 0xffff0000, v145
v_lshlrev_b32 v52, 16, v146
v_and_b32 v53, 0xffff0000, v146
v_lshlrev_b32 v54, 16, v147
v_and_b32 v55, 0xffff0000, v147
v_lshlrev_b32 v56, 16, v148
v_and_b32 v57, 0xffff0000, v148
v_lshlrev_b32 v58, 16, v149
v_and_b32 v59, 0xffff0000, v149
v_lshlrev_b32 v60, 16, v150
v_and_b32 v61, 0xffff0000, v150
v_lshlrev_b32 v62, 16, v151
v_and_b32 v63, 0xffff0000, v151
v_pk_add_f32 v[16:17], v[16:17], v[24:25]
v_pk_add_f32 v[18:19], v[18:19], v[26:27]
v_pk_add_f32 v[20:21], v[20:21], v[28:29]
v_pk_add_f32 v[22:23], v[22:23], v[30:31]
v_pk_add_f32 v[32:33], v[32:33], v[40:41]
v_pk_add_f32 v[34:35], v[34:35], v[42:43]
v_pk_add_f32 v[36:37], v[36:37], v[44:45]
v_pk_add_f32 v[38:39], v[38:39], v[46:47]
v_pk_add_f32 v[48:49], v[48:49], v[56:57]
v_pk_add_f32 v[50:51], v[50:51], v[58:59]
v_pk_add_f32 v[52:53], v[52:53], v[60:61]
v_pk_add_f32 v[54:55], v[54:55], v[62:63]
v_permlane32_swap_b32 v16, v20
v_permlane32_swap_b32 v17, v21
v_permlane32_swap_b32 v18, v22
v_permlane32_swap_b32 v19, v23
v_permlane32_swap_b32 v32, v36
v_permlane32_swap_b32 v33, v37
v_permlane32_swap_b32 v34, v38
v_permlane32_swap_b32 v35, v39
v_permlane32_swap_b32 v48, v52
v_permlane32_swap_b32 v49, v53
v_permlane32_swap_b32 v50, v54
v_permlane32_swap_b32 v51, v55
v_pk_add_f32 v[16:17], v[16:17], v[20:21]
v_pk_add_f32 v[18:19], v[18:19], v[22:23]
v_pk_add_f32 v[32:33], v[32:33], v[36:37]
v_pk_add_f32 v[34:35], v[34:35], v[38:39]
v_pk_add_f32 v[48:49], v[48:49], v[52:53]
v_pk_add_f32 v[50:51], v[50:51], v[54:55]
v_permlane16_swap_b32 v16, v18
v_permlane16_swap_b32 v17, v19
v_permlane16_swap_b32 v32, v34
v_permlane16_swap_b32 v33, v35
v_permlane16_swap_b32 v48, v50
v_permlane16_swap_b32 v49, v51
v_pk_add_f32 v[16:17], v[16:17], v[18:19]
v_pk_add_f32 v[32:33], v[32:33], v[34:35]
v_pk_add_f32 v[48:49], v[48:49], v[50:51]
v_add_f32_dpp v18, v16, v16 row_ror:8 row_mask:0xf bank_mask:0xf
v_add_f32_dpp v19, v17, v17 row_ror:8 row_mask:0xf bank_mask:0xf
v_add_f32_dpp v34, v32, v32 row_ror:8 row_mask:0xf bank_mask:0xf
v_add_f32_dpp v35, v33, v33 row_ror:8 row_mask:0xf bank_mask:0xf
v_add_f32_dpp v50, v48, v48 row_ror:8 row_mask:0xf bank_mask:0xf
v_add_f32_dpp v51, v49, v49 row_ror:8 row_mask:0xf bank_mask:0xf
v_and_b32 v5, 8, v1
v_cmp_eq_u32 vcc, 0, v5
v_lshrrev_b32 v5, 5, v1
v_lshlrev_b32 v5, 2, v5
v_bfe_u32 v6, v1, 4, 1
v_lshl_add_u32 v5, v6, 1, v5
v_bfe_u32 v6, v1, 3, 1
v_add_u32 v5, v5, v6
v_lshl_add_u32 v5, v11, 3, v5
s_mul_i32 s87, s72, 768
s_add_u32 s87, s87, 124672
v_lshl_add_u32 v5, v5, 2, s87
v_cndmask_b32 v16, v19, v18, vcc
v_cndmask_b32 v32, v35, v34, vcc
v_cndmask_b32 v48, v51, v50, vcc
ds_write_b32 v5, v16 offset:0
ds_write_b32 v5, v32 offset:256
ds_write_b32 v5, v48 offset:512
v_mov_b64 v[160:161], -1
v_mov_b64 v[162:163], -1
s_min_u32 s87, s79, 223
s_lshr_b32 s88, s87, 2
s_lshl_b32 s88, s88, 13
s_and_b32 s89, s87, 3
s_lshl_b32 s89, s89, 10
s_add_u32 s88, s88, s89
s_lshr_b32 s89, s72, 1
s_lshl_b32 s89, s89, 12
s_add_u32 s88, s88, s89
s_and_b32 s89, s72, 1
s_lshl_b32 s89, s89, 9
s_add_u32 s88, s88, s89
s_add_u32 s88, s88, 14155776
v_and_b32 v5, 31, v1
v_lshl_add_u32 v5, v5, 4, s88
buffer_store_dwordx4 v[160:163], v5, s[44:47], 0 offen sc1
s_lshl_b32 s87, s87, 10
s_lshl_b32 s88, s72, 8
s_add_u32 s87, s87, s88
s_add_u32 s87, s87, 14680064
v_and_b32 v5, 15, v1
v_lshl_add_u32 v5, v5, 4, s87
buffer_store_dwordx4 v[160:163], v5, s[44:47], 0 offen sc1
v_mov_b64 v[16:17], 0
v_mov_b64 v[18:19], 0
v_mov_b64 v[20:21], 0
v_mov_b64 v[22:23], 0
v_mov_b64 v[24:25], 0
v_mov_b64 v[26:27], 0
v_mov_b64 v[28:29], 0
v_mov_b64 v[30:31], 0
v_mov_b64 v[32:33], 0
v_mov_b64 v[34:35], 0
v_mov_b64 v[36:37], 0
v_mov_b64 v[38:39], 0
v_mov_b64 v[40:41], 0
v_mov_b64 v[42:43], 0
v_mov_b64 v[44:45], 0
v_mov_b64 v[46:47], 0
v_mov_b64 v[48:49], 0
v_mov_b64 v[50:51], 0
v_mov_b64 v[52:53], 0
v_mov_b64 v[54:55], 0
v_mov_b64 v[56:57], 0
v_mov_b64 v[58:59], 0
v_mov_b64 v[60:61], 0
v_mov_b64 v[62:63], 0
v_mov_b64 v[64:65], 0
v_mov_b64 v[66:67], 0
v_mov_b64 v[68:69], 0
v_mov_b64 v[70:71], 0
v_mov_b64 v[72:73], 0
v_mov_b64 v[74:75], 0
v_mov_b64 v[76:77], 0
v_mov_b64 v[78:79], 0
v_mov_b64 v[80:81], 0
v_mov_b64 v[82:83], 0
v_mov_b64 v[84:85], 0
v_mov_b64 v[86:87], 0
v_mov_b64 v[88:89], 0
v_mov_b64 v[90:91], 0
v_mov_b64 v[92:93], 0
v_mov_b64 v[94:95], 0
v_mov_b64 v[96:97], 0
v_mov_b64 v[98:99], 0
v_mov_b64 v[100:101], 0
v_mov_b64 v[102:103], 0
v_mov_b64 v[104:105], 0
v_mov_b64 v[106:107], 0
v_mov_b64 v[108:109], 0
v_mov_b64 v[110:111], 0
s_waitcnt lgkmcnt(0)
s_barrier
ds_read_b128 v[112:115], v196 offset:0
ds_read_b64_tr_b16 v[128:129], v198 offset:0
ds_read_b64_tr_b16 v[130:131], v198 offset:512
ds_read_b128 v[116:119], v196 offset:2048
ds_read_b128 v[120:123], v196 offset:4096
ds_read_b128 v[124:127], v196 offset:6144
ds_read_b64_tr_b16 v[132:133], v199 offset:0
ds_read_b64_tr_b16 v[134:135], v199 offset:512
ds_read_b64_tr_b16 v[136:137], v198 offset:8192
ds_read_b64_tr_b16 v[138:139], v198 offset:8704
ds_read_b64_tr_b16 v[140:141], v199 offset:8192
ds_read_b64_tr_b16 v[142:143], v199 offset:8704
ds_read_b64_tr_b16 v[144:145], v198 offset:16384
ds_read_b64_tr_b16 v[146:147], v198 offset:16896
ds_read_b64_tr_b16 v[148:149], v199 offset:16384
ds_read_b64_tr_b16 v[150:151], v199 offset:16896
s_mov_b32 s81, 15
L_p1_cloop:
s_waitcnt lgkmcnt(0)
v_mfma_f32_16x16x32_bf16 v[16:19], v[128:131], v[112:115], v[16:19]
ds_read_b128 v[152:155], v197 offset:0
v_mfma_f32_16x16x32_bf16 v[20:23], v[128:131], v[116:119], v[20:23]
ds_read_b64_tr_b16 v[168:169], v198 offset:4096
v_mfma_f32_16x16x32_bf16 v[24:27], v[128:131], v[120:123], v[24:27]
ds_read_b64_tr_b16 v[170:171], v198 offset:4608
v_mfma_f32_16x16x32_bf16 v[28:31], v[128:131], v[124:127], v[28:31]
ds_read_b128 v[156:159], v197 offset:2048
v_mfma_f32_16x16x32_bf16 v[44:47], v[132:135], v[124:127], v[44:47]
ds_read_b128 v[160:163], v197 offset:4096
v_mfma_f32_16x16x32_bf16 v[40:43], v[132:135], v[120:123], v[40:43]
ds_read_b128 v[164:167], v197 offset:6144
v_mfma_f32_16x16x32_bf16 v[36:39], v[132:135], v[116:119], v[36:39]
ds_read_b64_tr_b16 v[172:173], v199 offset:4096
v_mfma_f32_16x16x32_bf16 v[32:35], v[132:135], v[112:115], v[32:35]
ds_read_b64_tr_b16 v[174:175], v199 offset:4608
v_mfma_f32_16x16x32_bf16 v[48:51], v[136:139], v[112:115], v[48:51]
ds_read_b64_tr_b16 v[176:177], v198 offset:12288
v_mfma_f32_16x16x32_bf16 v[52:55], v[136:139], v[116:119], v[52:55]
ds_read_b64_tr_b16 v[178:179], v198 offset:12800
v_mfma_f32_16x16x32_bf16 v[56:59], v[136:139], v[120:123], v[56:59]
ds_read_b64_tr_b16 v[180:181], v199 offset:12288
v_mfma_f32_16x16x32_bf16 v[60:63], v[136:139], v[124:127], v[60:63]
ds_read_b64_tr_b16 v[182:183], v199 offset:12800
v_mfma_f32_16x16x32_bf16 v[76:79], v[140:143], v[124:127], v[76:79]
ds_read_b64_tr_b16 v[184:185], v198 offset:20480
v_mfma_f32_16x16x32_bf16 v[72:75], v[140:143], v[120:123], v[72:75]
ds_read_b64_tr_b16 v[186:187], v198 offset:20992
v_mfma_f32_16x16x32_bf16 v[68:71], v[140:143], v[116:119], v[68:71]
ds_read_b64_tr_b16 v[188:189], v199 offset:20480
v_mfma_f32_16x16x32_bf16 v[64:67], v[140:143], v[112:115], v[64:67]
ds_read_b64_tr_b16 v[190:191], v199 offset:20992
v_mfma_f32_16x16x32_bf16 v[80:83], v[112:115], v[144:147], v[80:83]
v_mfma_f32_16x16x32_bf16 v[88:91], v[116:119], v[144:147], v[88:91]
v_mfma_f32_16x16x32_bf16 v[96:99], v[120:123], v[144:147], v[96:99]
v_mfma_f32_16x16x32_bf16 v[104:107], v[124:127], v[144:147], v[104:107]
v_mfma_f32_16x16x32_bf16 v[108:111], v[124:127], v[148:151], v[108:111]
v_mfma_f32_16x16x32_bf16 v[100:103], v[120:123], v[148:151], v[100:103]
v_mfma_f32_16x16x32_bf16 v[92:95], v[116:119], v[148:151], v[92:95]
v_mfma_f32_16x16x32_bf16 v[84:87], v[112:115], v[148:151], v[84:87]
s_waitcnt lgkmcnt(0)
v_mfma_f32_16x16x32_bf16 v[16:19], v[168:171], v[152:155], v[16:19]
v_mfma_f32_16x16x32_bf16 v[20:23], v[168:171], v[156:159], v[20:23]
s_add_u32 s80, s80, 40960
s_cmp_eq_u32 s80, 122880
s_cselect_b32 s80, 0, s80
v_add_u32 v196, s80, v192
v_add_u32 v198, s80, v194
v_add_u32 v197, s80, v193
v_add_u32 v199, s80, v195
s_barrier
v_mfma_f32_16x16x32_bf16 v[24:27], v[168:171], v[160:163], v[24:27]
ds_read_b128 v[112:115], v196 offset:0
v_mfma_f32_16x16x32_bf16 v[28:31], v[168:171], v[164:167], v[28:31]
ds_read_b64_tr_b16 v[128:129], v198 offset:0
v_mfma_f32_16x16x32_bf16 v[44:47], v[172:175], v[164:167], v[44:47]
ds_read_b64_tr_b16 v[130:131], v198 offset:512
v_mfma_f32_16x16x32_bf16 v[40:43], v[172:175], v[160:163], v[40:43]
ds_read_b128 v[116:119], v196 offset:2048
v_mfma_f32_16x16x32_bf16 v[36:39], v[172:175], v[156:159], v[36:39]
ds_read_b128 v[120:123], v196 offset:4096
v_mfma_f32_16x16x32_bf16 v[32:35], v[172:175], v[152:155], v[32:35]
ds_read_b128 v[124:127], v196 offset:6144
v_mfma_f32_16x16x32_bf16 v[48:51], v[176:179], v[152:155], v[48:51]
ds_read_b64_tr_b16 v[132:133], v199 offset:0
v_mfma_f32_16x16x32_bf16 v[52:55], v[176:179], v[156:159], v[52:55]
ds_read_b64_tr_b16 v[134:135], v199 offset:512
v_mfma_f32_16x16x32_bf16 v[56:59], v[176:179], v[160:163], v[56:59]
ds_read_b64_tr_b16 v[136:137], v198 offset:8192
v_mfma_f32_16x16x32_bf16 v[60:63], v[176:179], v[164:167], v[60:63]
ds_read_b64_tr_b16 v[138:139], v198 offset:8704
v_mfma_f32_16x16x32_bf16 v[76:79], v[180:183], v[164:167], v[76:79]
ds_read_b64_tr_b16 v[140:141], v199 offset:8192
v_mfma_f32_16x16x32_bf16 v[72:75], v[180:183], v[160:163], v[72:75]
ds_read_b64_tr_b16 v[142:143], v199 offset:8704
v_mfma_f32_16x16x32_bf16 v[68:71], v[180:183], v[156:159], v[68:71]
ds_read_b64_tr_b16 v[144:145], v198 offset:16384
v_mfma_f32_16x16x32_bf16 v[64:67], v[180:183], v[152:155], v[64:67]
ds_read_b64_tr_b16 v[146:147], v198 offset:16896
v_mfma_f32_16x16x32_bf16 v[80:83], v[152:155], v[184:187], v[80:83]
ds_read_b64_tr_b16 v[148:149], v199 offset:16384
v_mfma_f32_16x16x32_bf16 v[88:91], v[156:159], v[184:187], v[88:91]
ds_read_b64_tr_b16 v[150:151], v199 offset:16896
v_mfma_f32_16x16x32_bf16 v[96:99], v[160:163], v[184:187], v[96:99]
v_mfma_f32_16x16x32_bf16 v[104:107], v[164:167], v[184:187], v[104:107]
v_mfma_f32_16x16x32_bf16 v[108:111], v[164:167], v[188:191], v[108:111]
v_mfma_f32_16x16x32_bf16 v[100:103], v[160:163], v[188:191], v[100:103]
v_mfma_f32_16x16x32_bf16 v[92:95], v[156:159], v[188:191], v[92:95]
v_mfma_f32_16x16x32_bf16 v[84:87], v[152:155], v[188:191], v[84:87]
s_cmp_lg_u32 s81, 5
s_cbranch_scc1 L_p1_nowait
s_waitcnt vmcnt(0)
L_p1_nowait:
s_sub_u32 s81, s81, 1
s_cmp_lg_u32 s81, 0
s_cbranch_scc1 L_p1_cloop
s_waitcnt lgkmcnt(0)
v_mfma_f32_16x16x32_bf16 v[16:19], v[128:131], v[112:115], v[16:19]
ds_read_b128 v[152:155], v197 offset:0
v_mfma_f32_16x16x32_bf16 v[20:23], v[128:131], v[116:119], v[20:23]
ds_read_b64_tr_b16 v[168:169], v198 offset:4096
v_mfma_f32_16x16x32_bf16 v[24:27], v[128:131], v[120:123], v[24:27]
ds_read_b64_tr_b16 v[170:171], v198 offset:4608
v_mfma_f32_16x16x32_bf16 v[28:31], v[128:131], v[124:127], v[28:31]
ds_read_b128 v[156:159], v197 offset:2048
v_mfma_f32_16x16x32_bf16 v[44:47], v[132:135], v[124:127], v[44:47]
ds_read_b128 v[160:163], v197 offset:4096
v_mfma_f32_16x16x32_bf16 v[40:43], v[132:135], v[120:123], v[40:43]
ds_read_b128 v[164:167], v197 offset:6144
v_mfma_f32_16x16x32_bf16 v[36:39], v[132:135], v[116:119], v[36:39]
ds_read_b64_tr_b16 v[172:173], v199 offset:4096
v_mfma_f32_16x16x32_bf16 v[32:35], v[132:135], v[112:115], v[32:35]
ds_read_b64_tr_b16 v[174:175], v199 offset:4608
v_mfma_f32_16x16x32_bf16 v[48:51], v[136:139], v[112:115], v[48:51]
ds_read_b64_tr_b16 v[176:177], v198 offset:12288
v_mfma_f32_16x16x32_bf16 v[52:55], v[136:139], v[116:119], v[52:55]
ds_read_b64_tr_b16 v[178:179], v198 offset:12800
v_mfma_f32_16x16x32_bf16 v[56:59], v[136:139], v[120:123], v[56:59]
ds_read_b64_tr_b16 v[180:181], v199 offset:12288
v_mfma_f32_16x16x32_bf16 v[60:63], v[136:139], v[124:127], v[60:63]
ds_read_b64_tr_b16 v[182:183], v199 offset:12800
v_mfma_f32_16x16x32_bf16 v[76:79], v[140:143], v[124:127], v[76:79]
ds_read_b64_tr_b16 v[184:185], v198 offset:20480
v_mfma_f32_16x16x32_bf16 v[72:75], v[140:143], v[120:123], v[72:75]
ds_read_b64_tr_b16 v[186:187], v198 offset:20992
v_mfma_f32_16x16x32_bf16 v[68:71], v[140:143], v[116:119], v[68:71]
ds_read_b64_tr_b16 v[188:189], v199 offset:20480
v_mfma_f32_16x16x32_bf16 v[64:67], v[140:143], v[112:115], v[64:67]
ds_read_b64_tr_b16 v[190:191], v199 offset:20992
v_mfma_f32_16x16x32_bf16 v[80:83], v[112:115], v[144:147], v[80:83]
v_mfma_f32_16x16x32_bf16 v[88:91], v[116:119], v[144:147], v[88:91]
v_mfma_f32_16x16x32_bf16 v[96:99], v[120:123], v[144:147], v[96:99]
v_mfma_f32_16x16x32_bf16 v[104:107], v[124:127], v[144:147], v[104:107]
v_mfma_f32_16x16x32_bf16 v[108:111], v[124:127], v[148:151], v[108:111]
v_mfma_f32_16x16x32_bf16 v[100:103], v[120:123], v[148:151], v[100:103]
v_mfma_f32_16x16x32_bf16 v[92:95], v[116:119], v[148:151], v[92:95]
v_mfma_f32_16x16x32_bf16 v[84:87], v[112:115], v[148:151], v[84:87]
s_waitcnt lgkmcnt(0)
v_mfma_f32_16x16x32_bf16 v[16:19], v[168:171], v[152:155], v[16:19]
v_mfma_f32_16x16x32_bf16 v[20:23], v[168:171], v[156:159], v[20:23]
s_barrier
v_mfma_f32_16x16x32_bf16 v[24:27], v[168:171], v[160:163], v[24:27]
ds_read2_b32 v[210:211], v205 offset0:0 offset1:16
v_mfma_f32_16x16x32_bf16 v[28:31], v[168:171], v[164:167], v[28:31]
ds_read2_b32 v[212:213], v205 offset0:32 offset1:48
v_mfma_f32_16x16x32_bf16 v[44:47], v[172:175], v[164:167], v[44:47]
ds_read2_b32 v[214:215], v205 offset0:128 offset1:144
v_mfma_f32_16x16x32_bf16 v[40:43], v[172:175], v[160:163], v[40:43]
ds_read2_b32 v[216:217], v205 offset0:160 offset1:176
v_mfma_f32_16x16x32_bf16 v[36:39], v[172:175], v[156:159], v[36:39]
ds_read_b128 v[218:221], v206 offset:256
v_mfma_f32_16x16x32_bf16 v[32:35], v[172:175], v[152:155], v[32:35]
ds_read_b128 v[222:225], v206 offset:320
v_mfma_f32_16x16x32_bf16 v[48:51], v[176:179], v[152:155], v[48:51]
ds_read_b32 v226, v207 offset:512
v_mfma_f32_16x16x32_bf16 v[52:55], v[176:179], v[156:159], v[52:55]
ds_read_b32 v227, v207 offset:576
v_mfma_f32_16x16x32_bf16 v[56:59], v[176:179], v[160:163], v[56:59]
ds_read_b128 v[112:115], v208 offset:0
v_mfma_f32_16x16x32_bf16 v[60:63], v[176:179], v[164:167], v[60:63]
ds_read_b128 v[128:131], v208 offset:512
v_mfma_f32_16x16x32_bf16 v[76:79], v[180:183], v[164:167], v[76:79]
ds_read_b128 v[116:119], v208 offset:64
v_mfma_f32_16x16x32_bf16 v[72:75], v[180:183], v[160:163], v[72:75]
ds_read_b128 v[132:135], v208 offset:576
v_mfma_f32_16x16x32_bf16 v[68:71], v[180:183], v[156:159], v[68:71]
ds_read_b128 v[120:123], v208 offset:128
v_mfma_f32_16x16x32_bf16 v[64:67], v[180:183], v[152:155], v[64:67]
ds_read_b128 v[136:139], v208 offset:640
v_mfma_f32_16x16x32_bf16 v[80:83], v[152:155], v[184:187], v[80:83]
ds_read_b128 v[124:127], v208 offset:192
v_mfma_f32_16x16x32_bf16 v[88:91], v[156:159], v[184:187], v[88:91]
ds_read_b128 v[140:143], v208 offset:704
v_mfma_f32_16x16x32_bf16 v[96:99], v[160:163], v[184:187], v[96:99]
ds_read_b128 v[144:147], v206 offset:0
v_mfma_f32_16x16x32_bf16 v[104:107], v[164:167], v[184:187], v[104:107]
ds_read_b128 v[148:151], v206 offset:64
v_mfma_f32_16x16x32_bf16 v[108:111], v[164:167], v[188:191], v[108:111]
v_mfma_f32_16x16x32_bf16 v[100:103], v[160:163], v[188:191], v[100:103]
v_mfma_f32_16x16x32_bf16 v[92:95], v[156:159], v[188:191], v[92:95]
v_mfma_f32_16x16x32_bf16 v[84:87], v[152:155], v[188:191], v[84:87]
s_waitcnt lgkmcnt(0)
s_mov_b32 s89, 4096
v_pk_fma_f32 v[48:49], v[218:219], v[210:211], v[48:49] op_sel:[0,0,0] op_sel_hi:[1,0,1] neg_lo:[0,1,0] neg_hi:[0,1,0]
v_pk_fma_f32 v[50:51], v[220:221], v[210:211], v[50:51] op_sel:[0,0,0] op_sel_hi:[1,0,1] neg_lo:[0,1,0] neg_hi:[0,1,0]
v_pk_fma_f32 v[64:65], v[222:223], v[210:211], v[64:65] op_sel:[0,0,0] op_sel_hi:[1,0,1] neg_lo:[0,1,0] neg_hi:[0,1,0]
v_pk_fma_f32 v[66:67], v[224:225], v[210:211], v[66:67] op_sel:[0,0,0] op_sel_hi:[1,0,1] neg_lo:[0,1,0] neg_hi:[0,1,0]
v_pk_fma_f32 v[52:53], v[218:219], v[210:211], v[52:53] op_sel:[0,1,0] op_sel_hi:[1,1,1] neg_lo:[0,1,0] neg_hi:[0,1,0]
v_pk_fma_f32 v[54:55], v[220:221], v[210:211], v[54:55] op_sel:[0,1,0] op_sel_hi:[1,1,1] neg_lo:[0,1,0] neg_hi:[0,1,0]
v_pk_fma_f32 v[68:69], v[222:223], v[210:211], v[68:69] op_sel:[0,1,0] op_sel_hi:[1,1,1] neg_lo:[0,1,0] neg_hi:[0,1,0]
v_pk_fma_f32 v[70:71], v[224:225], v[210:211], v[70:71] op_sel:[0,1,0] op_sel_hi:[1,1,1] neg_lo:[0,1,0] neg_hi:[0,1,0]
v_pk_mul_f32 v[48:49], v[48:49], v[214:215] op_sel:[0,0] op_sel_hi:[1,0]
v_pk_mul_f32 v[50:51], v[50:51], v[214:215] op_sel:[0,0] op_sel_hi:[1,0]
v_pk_mul_f32 v[64:65], v[64:65], v[214:215] op_sel:[0,0] op_sel_hi:[1,0]
v_pk_mul_f32 v[66:67], v[66:67], v[214:215] op_sel:[0,0] op_sel_hi:[1,0]
v_pk_mul_f32 v[52:53], v[52:53], v[214:215] op_sel:[0,1] op_sel_hi:[1,1]
v_pk_mul_f32 v[54:55], v[54:55], v[214:215] op_sel:[0,1] op_sel_hi:[1,1]
v_pk_mul_f32 v[68:69], v[68:69], v[214:215] op_sel:[0,1] op_sel_hi:[1,1]
v_pk_mul_f32 v[70:71], v[70:71], v[214:215] op_sel:[0,1] op_sel_hi:[1,1]
v_cvt_pk_bf16_f32 v152, v48, v49
v_cvt_pk_bf16_f32 v153, v50, v51
v_cvt_pk_bf16_f32 v154, v64, v65
v_cvt_pk_bf16_f32 v155, v66, v67
v_cvt_pk_bf16_f32 v156, v52, v53
v_cvt_pk_bf16_f32 v157, v54, v55
v_cvt_pk_bf16_f32 v158, v68, v69
v_cvt_pk_bf16_f32 v159, v70, v71
buffer_store_dwordx4 v[152:155], v203, s[44:47], 0 offen offset:0 sc1
buffer_store_dwordx4 v[156:159], v203, s[44:47], 0 offen offset:128 sc1
ds_write_b128 v200, v[152:155] offset:0
ds_write_b128 v200, v[156:159] offset:128
v_pk_fma_f32 v[56:57], v[218:219], v[212:213], v[56:57] op_sel:[0,0,0] op_sel_hi:[1,0,1] neg_lo:[0,1,0] neg_hi:[0,1,0]
v_pk_fma_f32 v[58:59], v[220:221], v[212:213], v[58:59] op_sel:[0,0,0] op_sel_hi:[1,0,1] neg_lo:[0,1,0] neg_hi:[0,1,0]
v_pk_fma_f32 v[72:73], v[222:223], v[212:213], v[72:73] op_sel:[0,0,0] op_sel_hi:[1,0,1] neg_lo:[0,1,0] neg_hi:[0,1,0]
v_pk_fma_f32 v[74:75], v[224:225], v[212:213], v[74:75] op_sel:[0,0,0] op_sel_hi:[1,0,1] neg_lo:[0,1,0] neg_hi:[0,1,0]
v_pk_fma_f32 v[60:61], v[218:219], v[212:213], v[60:61] op_sel:[0,1,0] op_sel_hi:[1,1,1] neg_lo:[0,1,0] neg_hi:[0,1,0]
v_pk_fma_f32 v[62:63], v[220:221], v[212:213], v[62:63] op_sel:[0,1,0] op_sel_hi:[1,1,1] neg_lo:[0,1,0] neg_hi:[0,1,0]
v_pk_fma_f32 v[76:77], v[222:223], v[212:213], v[76:77] op_sel:[0,1,0] op_sel_hi:[1,1,1] neg_lo:[0,1,0] neg_hi:[0,1,0]
v_pk_fma_f32 v[78:79], v[224:225], v[212:213], v[78:79] op_sel:[0,1,0] op_sel_hi:[1,1,1] neg_lo:[0,1,0] neg_hi:[0,1,0]
v_pk_mul_f32 v[56:57], v[56:57], v[216:217] op_sel:[0,0] op_sel_hi:[1,0]
v_pk_mul_f32 v[58:59], v[58:59], v[216:217] op_sel:[0,0] op_sel_hi:[1,0]
v_pk_mul_f32 v[72:73], v[72:73], v[216:217] op_sel:[0,0] op_sel_hi:[1,0]
v_pk_mul_f32 v[74:75], v[74:75], v[216:217] op_sel:[0,0] op_sel_hi:[1,0]
v_pk_mul_f32 v[60:61], v[60:61], v[216:217] op_sel:[0,1] op_sel_hi:[1,1]
v_pk_mul_f32 v[62:63], v[62:63], v[216:217] op_sel:[0,1] op_sel_hi:[1,1]
v_pk_mul_f32 v[76:77], v[76:77], v[216:217] op_sel:[0,1] op_sel_hi:[1,1]
v_pk_mul_f32 v[78:79], v[78:79], v[216:217] op_sel:[0,1] op_sel_hi:[1,1]
v_cvt_pk_bf16_f32 v160, v56, v57
v_cvt_pk_bf16_f32 v161, v58, v59
v_cvt_pk_bf16_f32 v162, v72, v73
v_cvt_pk_bf16_f32 v163, v74, v75
v_cvt_pk_bf16_f32 v164, v60, v61
v_cvt_pk_bf16_f32 v165, v62, v63
v_cvt_pk_bf16_f32 v166, v76, v77
v_cvt_pk_bf16_f32 v167, v78, v79
buffer_store_dwordx4 v[160:163], v203, s[44:47], s89 offen offset:0 sc1
buffer_store_dwordx4 v[164:167], v203, s[44:47], s89 offen offset:128 sc1
ds_write_b128 v200, v[160:163] offset:4096
ds_write_b128 v200, v[164:167] offset:4224
v_pk_fma_f32 v[80:81], v[112:113], v[226:227], v[80:81] op_sel:[0,0,0] op_sel_hi:[1,0,1] neg_lo:[0,1,0] neg_hi:[0,1,0]
v_pk_fma_f32 v[82:83], v[114:115], v[226:227], v[82:83] op_sel:[0,0,0] op_sel_hi:[1,0,1] neg_lo:[0,1,0] neg_hi:[0,1,0]
v_pk_fma_f32 v[84:85], v[112:113], v[226:227], v[84:85] op_sel:[0,1,0] op_sel_hi:[1,1,1] neg_lo:[0,1,0] neg_hi:[0,1,0]
v_pk_fma_f32 v[86:87], v[114:115], v[226:227], v[86:87] op_sel:[0,1,0] op_sel_hi:[1,1,1] neg_lo:[0,1,0] neg_hi:[0,1,0]
v_pk_fma_f32 v[88:89], v[116:117], v[226:227], v[88:89] op_sel:[0,0,0] op_sel_hi:[1,0,1] neg_lo:[0,1,0] neg_hi:[0,1,0]
v_pk_fma_f32 v[90:91], v[118:119], v[226:227], v[90:91] op_sel:[0,0,0] op_sel_hi:[1,0,1] neg_lo:[0,1,0] neg_hi:[0,1,0]
v_pk_fma_f32 v[92:93], v[116:117], v[226:227], v[92:93] op_sel:[0,1,0] op_sel_hi:[1,1,1] neg_lo:[0,1,0] neg_hi:[0,1,0]
v_pk_fma_f32 v[94:95], v[118:119], v[226:227], v[94:95] op_sel:[0,1,0] op_sel_hi:[1,1,1] neg_lo:[0,1,0] neg_hi:[0,1,0]
v_pk_mul_f32 v[80:81], v[80:81], v[128:129]
v_pk_mul_f32 v[82:83], v[82:83], v[130:131]
v_pk_mul_f32 v[84:85], v[84:85], v[128:129]
v_pk_mul_f32 v[86:87], v[86:87], v[130:131]
v_pk_mul_f32 v[88:89], v[88:89], v[132:133]
v_pk_mul_f32 v[90:91], v[90:91], v[134:135]
v_pk_mul_f32 v[92:93], v[92:93], v[132:133]
v_pk_mul_f32 v[94:95], v[94:95], v[134:135]
v_cvt_pk_bf16_f32 v168, v80, v81
v_cvt_pk_bf16_f32 v169, v82, v83
v_cvt_pk_bf16_f32 v170, v88, v89
v_cvt_pk_bf16_f32 v171, v90, v91
v_cvt_pk_bf16_f32 v172, v84, v85
v_cvt_pk_bf16_f32 v173, v86, v87
v_cvt_pk_bf16_f32 v174, v92, v93
v_cvt_pk_bf16_f32 v175, v94, v95
buffer_store_dwordx4 v[168:171], v204, s[44:47], 0 offen offset:2048 sc1
buffer_store_dwordx4 v[172:175], v204, s[44:47], 0 offen offset:2304 sc1
ds_write_b128 v201, v[168:171] offset:2048
ds_write_b128 v201, v[172:175] offset:2304
v_pk_fma_f32 v[96:97], v[120:121], v[226:227], v[96:97] op_sel:[0,0,0] op_sel_hi:[1,0,1] neg_lo:[0,1,0] neg_hi:[0,1,0]
v_pk_fma_f32 v[98:99], v[122:123], v[226:227], v[98:99] op_sel:[0,0,0] op_sel_hi:[1,0,1] neg_lo:[0,1,0] neg_hi:[0,1,0]
v_pk_fma_f32 v[100:101], v[120:121], v[226:227], v[100:101] op_sel:[0,1,0] op_sel_hi:[1,1,1] neg_lo:[0,1,0] neg_hi:[0,1,0]
v_pk_fma_f32 v[102:103], v[122:123], v[226:227], v[102:103] op_sel:[0,1,0] op_sel_hi:[1,1,1] neg_lo:[0,1,0] neg_hi:[0,1,0]
v_pk_fma_f32 v[104:105], v[124:125], v[226:227], v[104:105] op_sel:[0,0,0] op_sel_hi:[1,0,1] neg_lo:[0,1,0] neg_hi:[0,1,0]
v_pk_fma_f32 v[106:107], v[126:127], v[226:227], v[106:107] op_sel:[0,0,0] op_sel_hi:[1,0,1] neg_lo:[0,1,0] neg_hi:[0,1,0]
v_pk_fma_f32 v[108:109], v[124:125], v[226:227], v[108:109] op_sel:[0,1,0] op_sel_hi:[1,1,1] neg_lo:[0,1,0] neg_hi:[0,1,0]
v_pk_fma_f32 v[110:111], v[126:127], v[226:227], v[110:111] op_sel:[0,1,0] op_sel_hi:[1,1,1] neg_lo:[0,1,0] neg_hi:[0,1,0]
v_pk_mul_f32 v[96:97], v[96:97], v[136:137]
v_pk_mul_f32 v[98:99], v[98:99], v[138:139]
v_pk_mul_f32 v[100:101], v[100:101], v[136:137]
v_pk_mul_f32 v[102:103], v[102:103], v[138:139]
v_pk_mul_f32 v[104:105], v[104:105], v[140:141]
v_pk_mul_f32 v[106:107], v[106:107], v[142:143]
v_pk_mul_f32 v[108:109], v[108:109], v[140:141]
v_pk_mul_f32 v[110:111], v[110:111], v[142:143]
v_cvt_pk_bf16_f32 v176, v96, v97
v_cvt_pk_bf16_f32 v177, v98, v99
v_cvt_pk_bf16_f32 v178, v104, v105
v_cvt_pk_bf16_f32 v179, v106, v107
v_cvt_pk_bf16_f32 v180, v100, v101
v_cvt_pk_bf16_f32 v181, v102, v103
v_cvt_pk_bf16_f32 v182, v108, v109
v_cvt_pk_bf16_f32 v183, v110, v111
buffer_store_dwordx4 v[176:179], v204, s[44:47], s89 offen offset:2048 sc1
buffer_store_dwordx4 v[180:183], v204, s[44:47], s89 offen offset:2304 sc1
ds_write_b128 v201, v[176:179] offset:6144
ds_write_b128 v201, v[180:183] offset:6400
s_mov_b32 s89, 0x3e8293ee
v_mul_f32 v214, s89, v214
v_mul_f32 v215, s89, v215
v_mul_f32 v216, s89, v216
v_mul_f32 v217, s89, v217
v_pk_fma_f32 v[16:17], v[144:145], v[210:211], v[16:17] op_sel:[0,0,0] op_sel_hi:[1,0,1] neg_lo:[0,1,0] neg_hi:[0,1,0]
v_pk_fma_f32 v[18:19], v[146:147], v[210:211], v[18:19] op_sel:[0,0,0] op_sel_hi:[1,0,1] neg_lo:[0,1,0] neg_hi:[0,1,0]
v_pk_fma_f32 v[32:33], v[148:149], v[210:211], v[32:33] op_sel:[0,0,0] op_sel_hi:[1,0,1] neg_lo:[0,1,0] neg_hi:[0,1,0]
v_pk_fma_f32 v[34:35], v[150:151], v[210:211], v[34:35] op_sel:[0,0,0] op_sel_hi:[1,0,1] neg_lo:[0,1,0] neg_hi:[0,1,0]
v_pk_fma_f32 v[20:21], v[144:145], v[210:211], v[20:21] op_sel:[0,1,0] op_sel_hi:[1,1,1] neg_lo:[0,1,0] neg_hi:[0,1,0]
v_pk_fma_f32 v[22:23], v[146:147], v[210:211], v[22:23] op_sel:[0,1,0] op_sel_hi:[1,1,1] neg_lo:[0,1,0] neg_hi:[0,1,0]
v_pk_fma_f32 v[36:37], v[148:149], v[210:211], v[36:37] op_sel:[0,1,0] op_sel_hi:[1,1,1] neg_lo:[0,1,0] neg_hi:[0,1,0]
v_pk_fma_f32 v[38:39], v[150:151], v[210:211], v[38:39] op_sel:[0,1,0] op_sel_hi:[1,1,1] neg_lo:[0,1,0] neg_hi:[0,1,0]
v_pk_mul_f32 v[16:17], v[16:17], v[214:215] op_sel:[0,0] op_sel_hi:[1,0]
v_pk_mul_f32 v[18:19], v[18:19], v[214:215] op_sel:[0,0] op_sel_hi:[1,0]
v_pk_mul_f32 v[32:33], v[32:33], v[214:215] op_sel:[0,0] op_sel_hi:[1,0]
v_pk_mul_f32 v[34:35], v[34:35], v[214:215] op_sel:[0,0] op_sel_hi:[1,0]
v_pk_mul_f32 v[20:21], v[20:21], v[214:215] op_sel:[0,1] op_sel_hi:[1,1]
v_pk_mul_f32 v[22:23], v[22:23], v[214:215] op_sel:[0,1] op_sel_hi:[1,1]
v_pk_mul_f32 v[36:37], v[36:37], v[214:215] op_sel:[0,1] op_sel_hi:[1,1]
v_pk_mul_f32 v[38:39], v[38:39], v[214:215] op_sel:[0,1] op_sel_hi:[1,1]
v_cvt_pk_bf16_f32 v152, v16, v17
v_cvt_pk_bf16_f32 v153, v18, v19
v_cvt_pk_bf16_f32 v154, v32, v33
v_cvt_pk_bf16_f32 v155, v34, v35
v_cvt_pk_bf16_f32 v156, v20, v21
v_cvt_pk_bf16_f32 v157, v22, v23
v_cvt_pk_bf16_f32 v158, v36, v37
v_cvt_pk_bf16_f32 v159, v38, v39
ds_write_b128 v202, v[152:155] offset:0
ds_write_b128 v202, v[156:159] offset:256
v_pk_fma_f32 v[24:25], v[144:145], v[212:213], v[24:25] op_sel:[0,0,0] op_sel_hi:[1,0,1] neg_lo:[0,1,0] neg_hi:[0,1,0]
v_pk_fma_f32 v[26:27], v[146:147], v[212:213], v[26:27] op_sel:[0,0,0] op_sel_hi:[1,0,1] neg_lo:[0,1,0] neg_hi:[0,1,0]
v_pk_fma_f32 v[40:41], v[148:149], v[212:213], v[40:41] op_sel:[0,0,0] op_sel_hi:[1,0,1] neg_lo:[0,1,0] neg_hi:[0,1,0]
v_pk_fma_f32 v[42:43], v[150:151], v[212:213], v[42:43] op_sel:[0,0,0] op_sel_hi:[1,0,1] neg_lo:[0,1,0] neg_hi:[0,1,0]
v_pk_fma_f32 v[28:29], v[144:145], v[212:213], v[28:29] op_sel:[0,1,0] op_sel_hi:[1,1,1] neg_lo:[0,1,0] neg_hi:[0,1,0]
v_pk_fma_f32 v[30:31], v[146:147], v[212:213], v[30:31] op_sel:[0,1,0] op_sel_hi:[1,1,1] neg_lo:[0,1,0] neg_hi:[0,1,0]
v_pk_fma_f32 v[44:45], v[148:149], v[212:213], v[44:45] op_sel:[0,1,0] op_sel_hi:[1,1,1] neg_lo:[0,1,0] neg_hi:[0,1,0]
v_pk_fma_f32 v[46:47], v[150:151], v[212:213], v[46:47] op_sel:[0,1,0] op_sel_hi:[1,1,1] neg_lo:[0,1,0] neg_hi:[0,1,0]
v_pk_mul_f32 v[24:25], v[24:25], v[216:217] op_sel:[0,0] op_sel_hi:[1,0]
v_pk_mul_f32 v[26:27], v[26:27], v[216:217] op_sel:[0,0] op_sel_hi:[1,0]
v_pk_mul_f32 v[40:41], v[40:41], v[216:217] op_sel:[0,0] op_sel_hi:[1,0]
v_pk_mul_f32 v[42:43], v[42:43], v[216:217] op_sel:[0,0] op_sel_hi:[1,0]
v_pk_mul_f32 v[28:29], v[28:29], v[216:217] op_sel:[0,1] op_sel_hi:[1,1]
v_pk_mul_f32 v[30:31], v[30:31], v[216:217] op_sel:[0,1] op_sel_hi:[1,1]
v_pk_mul_f32 v[44:45], v[44:45], v[216:217] op_sel:[0,1] op_sel_hi:[1,1]
v_pk_mul_f32 v[46:47], v[46:47], v[216:217] op_sel:[0,1] op_sel_hi:[1,1]
v_cvt_pk_bf16_f32 v160, v24, v25
v_cvt_pk_bf16_f32 v161, v26, v27
v_cvt_pk_bf16_f32 v162, v40, v41
v_cvt_pk_bf16_f32 v163, v42, v43
v_cvt_pk_bf16_f32 v164, v28, v29
v_cvt_pk_bf16_f32 v165, v30, v31
v_cvt_pk_bf16_f32 v166, v44, v45
v_cvt_pk_bf16_f32 v167, v46, v47
ds_write_b128 v202, v[160:163] offset:2048
ds_write_b128 v202, v[164:167] offset:2304
s_waitcnt lgkmcnt(0)
s_branch L_p1_join
L_p1_helper:
s_sub_u32 s80, s72, 4
s_mov_b32 s90, 0
v_lshrrev_b32 v2, 3, v1
v_and_b32 v4, 7, v1
s_lshl_b32 s81, s80, 5
s_lshl_b32 s82, s73, 7
s_add_u32 s81, s81, s82
v_add_u32 v5, s81, v2
v_lshlrev_b32 v5, 11, v5
v_lshrrev_b32 v6, 1, v2
v_xor_b32 v7, v6, v4
v_xor_b32 v6, 4, v7
v_lshl_add_u32 v8, v7, 4, v5
v_lshl_add_u32 v9, v6, 4, v5
v_add_u32 v9, 16384, v9
v_lshl_add_u32 v10, v7, 4, v5
v_add_u32 v10, 32768, v10
v_lshl_add_u32 v11, v6, 4, v5
v_add_u32 v11, 49152, v11
s_mov_b32 s91, 0
s_lshl_b32 s84, s80, 12
s_mul_i32 s85, s80, 6144
s_add_u32 s85, s85, 16384
s_add_u32 s81, s91, 0
s_and_b32 s81, s81, 15
s_lshl_b32 s82, s81, 7
s_mul_i32 s83, s81, 393216
s_add_u32 m0, s84, 0
s_nop 0
buffer_load_dwordx4 v8, s[36:39], s82 offen  lds
s_add_u32 m0, m0, 0x400
s_nop 0
buffer_load_dwordx4 v9, s[36:39], s82 offen  lds
s_add_u32 m0, m0, 0x400
s_nop 0
buffer_load_dwordx4 v10, s[36:39], s82 offen  lds
s_add_u32 m0, m0, 0x400
s_nop 0
buffer_load_dwordx4 v11, s[36:39], s82 offen  lds
v_bfe_u32 v5, v2, 1, 1
v_lshlrev_b32 v5, 2, v5
v_xor_b32 v5, v5, v4
s_mov_b32 s89, 6144
v_mul_lo_u32 v6, v2, s89
s_lshl_b32 s82, s74, 7
v_add_u32 v6, s82, v6
s_mul_i32 s81, s80, 6
s_add_u32 s81, s81, 0
s_lshr_b32 s82, s81, 3
s_and_b32 s81, s81, 7
s_lshl_b32 s82, s82, 11
s_mul_i32 s83, s81, 49152
s_add_u32 s82, s82, s83
s_and_b32 s81, s81, 1
s_lshl_b32 s81, s81, 1
v_xor_b32 v7, s81, v5
v_lshl_add_u32 v7, v7, 4, v6
v_add_u32 v12, s82, v7
s_mul_i32 s81, s80, 6
s_add_u32 s81, s81, 1
s_lshr_b32 s82, s81, 3
s_and_b32 s81, s81, 7
s_lshl_b32 s82, s82, 11
s_mul_i32 s83, s81, 49152
s_add_u32 s82, s82, s83
s_and_b32 s81, s81, 1
s_lshl_b32 s81, s81, 1
v_xor_b32 v7, s81, v5
v_lshl_add_u32 v7, v7, 4, v6
v_add_u32 v13, s82, v7
s_mul_i32 s81, s80, 6
s_add_u32 s81, s81, 2
s_lshr_b32 s82, s81, 3
s_and_b32 s81, s81, 7
s_lshl_b32 s82, s82, 11
s_mul_i32 s83, s81, 49152
s_add_u32 s82, s82, s83
s_and_b32 s81, s81, 1
s_lshl_b32 s81, s81, 1
v_xor_b32 v7, s81, v5
v_lshl_add_u32 v7, v7, 4, v6
v_add_u32 v14, s82, v7
s_mul_i32 s81, s80, 6
s_add_u32 s81, s81, 3
s_lshr_b32 s82, s81, 3
s_and_b32 s81, s81, 7
s_lshl_b32 s82, s82, 11
s_mul_i32 s83, s81, 49152
s_add_u32 s82, s82, s83
s_and_b32 s81, s81, 1
s_lshl_b32 s81, s81, 1
v_xor_b32 v7, s81, v5
v_lshl_add_u32 v7, v7, 4, v6
v_add_u32 v15, s82, v7
s_mul_i32 s81, s80, 6
s_add_u32 s81, s81, 4
s_lshr_b32 s82, s81, 3
s_and_b32 s81, s81, 7
s_lshl_b32 s82, s82, 11
s_mul_i32 s83, s81, 49152
s_add_u32 s82, s82, s83
s_and_b32 s81, s81, 1
s_lshl_b32 s81, s81, 1
v_xor_b32 v7, s81, v5
v_lshl_add_u32 v7, v7, 4, v6
v_add_u32 v16, s82, v7
s_mul_i32 s81, s80, 6
s_add_u32 s81, s81, 5
s_lshr_b32 s82, s81, 3
s_and_b32 s81, s81, 7
s_lshl_b32 s82, s82, 11
s_mul_i32 s83, s81, 49152
s_add_u32 s82, s82, s83
s_and_b32 s81, s81, 1
s_lshl_b32 s81, s81, 1
v_xor_b32 v7, s81, v5
v_lshl_add_u32 v7, v7, 4, v6
v_add_u32 v17, s82, v7
s_add_u32 s81, s91, 0
s_and_b32 s81, s81, 15
s_lshl_b32 s82, s81, 7
s_mul_i32 s83, s81, 393216
s_add_u32 m0, s85, 0
s_nop 0
buffer_load_dwordx4 v12, s[68:71], s83 offen  lds
s_add_u32 m0, m0, 0x400
s_nop 0
buffer_load_dwordx4 v13, s[68:71], s83 offen  lds
s_add_u32 m0, m0, 0x400
s_nop 0
buffer_load_dwordx4 v14, s[68:71], s83 offen  lds
s_add_u32 m0, m0, 0x400
s_nop 0
buffer_load_dwordx4 v15, s[68:71], s83 offen  lds
s_add_u32 m0, m0, 0x400
s_nop 0
buffer_load_dwordx4 v16, s[68:71], s83 offen  lds
s_add_u32 m0, m0, 0x400
s_nop 0
buffer_load_dwordx4 v17, s[68:71], s83 offen  lds
s_add_u32 s81, s91, 1
s_and_b32 s81, s81, 15
s_lshl_b32 s82, s81, 7
s_mul_i32 s83, s81, 393216
s_add_u32 m0, s84, 40960
s_nop 0
buffer_load_dwordx4 v8, s[36:39], s82 offen  lds
s_add_u32 m0, m0, 0x400
s_nop 0
buffer_load_dwordx4 v9, s[36:39], s82 offen  lds
s_add_u32 m0, m0, 0x400
s_nop 0
buffer_load_dwordx4 v10, s[36:39], s82 offen  lds
s_add_u32 m0, m0, 0x400
s_nop 0
buffer_load_dwordx4 v11, s[36:39], s82 offen  lds
s_add_u32 m0, s85, 40960
s_nop 0
buffer_load_dwordx4 v12, s[68:71], s83 offen  lds
s_add_u32 m0, m0, 0x400
s_nop 0
buffer_load_dwordx4 v13, s[68:71], s83 offen  lds
s_add_u32 m0, m0, 0x400
s_nop 0
buffer_load_dwordx4 v14, s[68:71], s83 offen  lds
s_add_u32 m0, m0, 0x400
s_nop 0
buffer_load_dwordx4 v15, s[68:71], s83 offen  lds
s_add_u32 m0, m0, 0x400
s_nop 0
buffer_load_dwordx4 v16, s[68:71], s83 offen  lds
s_add_u32 m0, m0, 0x400
s_nop 0
buffer_load_dwordx4 v17, s[68:71], s83 offen  lds
s_mov_b32 s40, s8
s_mov_b32 s41, s9
s_mov_b32 s42, 2097152
s_mov_b32 s43, 0x00020000
s_mov_b32 s48, s20
s_mov_b32 s49, s21
s_mov_b32 s50, 4194304
s_mov_b32 s51, 0x00020000
s_mov_b32 s52, s14
s_mov_b32 s53, s15
s_mov_b32 s54, 7340032
s_mov_b32 s55, 0x00020000
s_mov_b32 s56, s16
s_mov_b32 s57, s17
s_mov_b32 s58, 7340032
s_mov_b32 s59, 0x00020000
s_mov_b32 s60, s18
s_mov_b32 s61, s19
s_mov_b32 s62, 7340032
s_mov_b32 s63, 0x00020000
s_mov_b32 s64, s12
s_mov_b32 s65, s13
s_mov_b32 s66, 2048
s_mov_b32 s67, 0x00020000
s_waitcnt vmcnt(10)
v_readfirstlane_b32 s77, v3
s_nop 1
s_mul_i32 s77, s77, 1664525
s_add_u32 s77, s77, 1013904223
s_barrier
s_add_u32 s81, s91, 2
s_and_b32 s81, s81, 15
s_lshl_b32 s82, s81, 7
s_mul_i32 s83, s81, 393216
s_add_u32 m0, s84, 81920
s_nop 0
buffer_load_dwordx4 v8, s[36:39], s82 offen  lds
v_lshlrev_b32 v5, 2, v1
v_add_u32 v5, 124672, v5
ds_read_b32 v40, v5 offset:0
ds_read_b32 v41, v5 offset:256
s_add_u32 m0, m0, 0x400
s_nop 0
buffer_load_dwordx4 v9, s[36:39], s82 offen  lds
ds_read_b32 v42, v5 offset:512
ds_read_b32 v44, v5 offset:768
ds_read_b32 v45, v5 offset:1024
ds_read_b32 v46, v5 offset:1280
s_add_u32 m0, m0, 0x400
s_nop 0
buffer_load_dwordx4 v10, s[36:39], s82 offen  lds
ds_read_b32 v48, v5 offset:1536
ds_read_b32 v49, v5 offset:1792
ds_read_b32 v50, v5 offset:2048
ds_read_b32 v52, v5 offset:2304
s_add_u32 m0, m0, 0x400
s_nop 0
buffer_load_dwordx4 v11, s[36:39], s82 offen  lds
ds_read_b32 v53, v5 offset:2560
ds_read_b32 v54, v5 offset:2816
s_lshl_b32 s87, s74, 4
s_add_u32 s87, s87, s73
s_add_u32 m0, s85, 81920
s_nop 0
buffer_load_dwordx4 v12, s[68:71], s83 offen  lds
s_lshl_b32 s87, s87, 10
s_add_u32 s87, s87, 12648448
v_lshl_add_u32 v6, v1, 4, s87
s_waitcnt lgkmcnt(0)
s_add_u32 m0, m0, 0x400
s_nop 0
buffer_load_dwordx4 v13, s[68:71], s83 offen  lds
v_add_f32 v40, v40, v44
v_add_f32 v48, v48, v52
v_add_f32 v41, v41, v45
v_add_f32 v49, v49, v53
s_add_u32 m0, m0, 0x400
s_nop 0
buffer_load_dwordx4 v14, s[68:71], s83 offen  lds
v_add_f32 v42, v42, v46
v_add_f32 v50, v50, v54
v_add_f32 v40, v40, v48
v_add_f32 v41, v41, v49
s_add_u32 m0, m0, 0x400
s_nop 0
buffer_load_dwordx4 v15, s[68:71], s83 offen  lds
v_add_f32 v42, v42, v50
v_mov_b32 v43, s77
v_lshrrev_b32 v5, 4, v1
v_cmp_eq_u32 vcc, s80, v5
s_nop 1
s_and_saveexec_b64 s[96:97], vcc
buffer_store_dwordx4 v[40:43], v6, s[44:47], 0 offen sc1
s_mov_b64 exec, s[96:97]
s_add_u32 m0, m0, 0x400
s_nop 0
buffer_load_dwordx4 v16, s[68:71], s83 offen  lds
s_add_u32 m0, m0, 0x400
s_nop 0
buffer_load_dwordx4 v17, s[68:71], s83 offen  lds
s_waitcnt vmcnt(10)
s_barrier
s_add_u32 s81, s91, 3
s_and_b32 s81, s81, 15
s_lshl_b32 s82, s81, 7
s_mul_i32 s83, s81, 393216
s_add_u32 m0, s84, 0
s_nop 0
buffer_load_dwordx4 v8, s[36:39], s82 offen  lds
s_add_u32 m0, m0, 0x400
s_nop 0
buffer_load_dwordx4 v9, s[36:39], s82 offen  lds
s_add_u32 m0, m0, 0x400
s_nop 0
buffer_load_dwordx4 v10, s[36:39], s82 offen  lds
s_add_u32 m0, m0, 0x400
s_nop 0
buffer_load_dwordx4 v11, s[36:39], s82 offen  lds
s_add_u32 m0, s85, 0
s_nop 0
buffer_load_dwordx4 v12, s[68:71], s83 offen  lds
s_add_u32 m0, m0, 0x400
s_nop 0
buffer_load_dwordx4 v13, s[68:71], s83 offen  lds
s_add_u32 m0, m0, 0x400
s_nop 0
buffer_load_dwordx4 v14, s[68:71], s83 offen  lds
s_add_u32 m0, m0, 0x400
s_nop 0
buffer_load_dwordx4 v15, s[68:71], s83 offen  lds
s_add_u32 m0, m0, 0x400
s_nop 0
buffer_load_dwordx4 v16, s[68:71], s83 offen  lds
s_add_u32 m0, m0, 0x400
s_nop 0
buffer_load_dwordx4 v17, s[68:71], s83 offen  lds
s_waitcnt vmcnt(10)
s_barrier
s_add_u32 s81, s91, 4
s_and_b32 s81, s81, 15
s_lshl_b32 s82, s81, 7
s_mul_i32 s83, s81, 393216
s_add_u32 m0, s84, 40960
s_nop 0
buffer_load_dwordx4 v8, s[36:39], s82 offen  lds
s_lshl_b32 s87, s78, 13
s_add_u32 m0, m0, 0x400
s_nop 0
buffer_load_dwordx4 v9, s[36:39], s82 offen  lds
s_lshl_b32 s88, s80, 11
s_add_u32 m0, m0, 0x400
s_nop 0
buffer_load_dwordx4 v10, s[36:39], s82 offen  lds
s_add_u32 s87, s87, s88
s_add_u32 m0, m0, 0x400
s_nop 0
buffer_load_dwordx4 v11, s[36:39], s82 offen  lds
v_and_b32 v6, 15, v1
s_add_u32 m0, s85, 40960
s_nop 0
buffer_load_dwordx4 v12, s[68:71], s83 offen  lds
v_lshl_add_u32 v6, v6, 7, s87
s_add_u32 m0, m0, 0x400
s_nop 0
buffer_load_dwordx4 v13, s[68:71], s83 offen  lds
buffer_load_dword v48, v6, s[40:43], 0 offen
s_add_u32 m0, m0, 0x400
s_nop 0
buffer_load_dwordx4 v14, s[68:71], s83 offen  lds
s_add_u32 m0, m0, 0x400
s_nop 0
buffer_load_dwordx4 v15, s[68:71], s83 offen  lds
s_add_u32 m0, m0, 0x400
s_nop 0
buffer_load_dwordx4 v16, s[68:71], s83 offen  lds
s_add_u32 m0, m0, 0x400
s_nop 0
buffer_load_dwordx4 v17, s[68:71], s83 offen  lds
s_waitcnt vmcnt(11)
s_barrier
s_add_u32 s81, s91, 5
s_and_b32 s81, s81, 15
s_lshl_b32 s82, s81, 7
s_mul_i32 s83, s81, 393216
s_add_u32 m0, s84, 81920
s_nop 0
buffer_load_dwordx4 v8, s[36:39], s82 offen  lds
s_add_u32 m0, m0, 0x400
s_nop 0
buffer_load_dwordx4 v9, s[36:39], s82 offen  lds
s_add_u32 m0, m0, 0x400
s_nop 0
buffer_load_dwordx4 v10, s[36:39], s82 offen  lds
s_add_u32 m0, m0, 0x400
s_nop 0
buffer_load_dwordx4 v11, s[36:39], s82 offen  lds
s_add_u32 m0, s85, 81920
s_nop 0
buffer_load_dwordx4 v12, s[68:71], s83 offen  lds
s_add_u32 m0, m0, 0x400
s_nop 0
buffer_load_dwordx4 v13, s[68:71], s83 offen  lds
s_add_u32 m0, m0, 0x400
s_nop 0
buffer_load_dwordx4 v14, s[68:71], s83 offen  lds
s_add_u32 m0, m0, 0x400
s_nop 0
buffer_load_dwordx4 v15, s[68:71], s83 offen  lds
s_add_u32 m0, m0, 0x400
s_nop 0
buffer_load_dwordx4 v16, s[68:71], s83 offen  lds
s_add_u32 m0, m0, 0x400
s_nop 0
buffer_load_dwordx4 v17, s[68:71], s83 offen  lds
s_waitcnt vmcnt(10)
s_barrier
s_add_u32 s81, s91, 6
s_and_b32 s81, s81, 15
s_lshl_b32 s82, s81, 7
s_mul_i32 s83, s81, 393216
s_add_u32 m0, s84, 0
s_nop 0
buffer_load_dwordx4 v8, s[36:39], s82 offen  lds
s_add_u32 m0, m0, 0x400
s_nop 0
buffer_load_dwordx4 v9, s[36:39], s82 offen  lds
s_add_u32 m0, m0, 0x400
s_nop 0
buffer_load_dwordx4 v10, s[36:39], s82 offen  lds
s_add_u32 m0, m0, 0x400
s_nop 0
buffer_load_dwordx4 v11, s[36:39], s82 offen  lds
s_add_u32 m0, s85, 0
s_nop 0
buffer_load_dwordx4 v12, s[68:71], s83 offen  lds
s_add_u32 m0, m0, 0x400
s_nop 0
buffer_load_dwordx4 v13, s[68:71], s83 offen  lds
s_add_u32 m0, m0, 0x400
s_nop 0
buffer_load_dwordx4 v14, s[68:71], s83 offen  lds
s_add_u32 m0, m0, 0x400
s_nop 0
buffer_load_dwordx4 v15, s[68:71], s83 offen  lds
s_add_u32 m0, m0, 0x400
s_nop 0
buffer_load_dwordx4 v16, s[68:71], s83 offen  lds
s_add_u32 m0, m0, 0x400
s_nop 0
buffer_load_dwordx4 v17, s[68:71], s83 offen  lds
s_waitcnt vmcnt(10)
s_barrier
s_add_u32 s81, s91, 7
s_and_b32 s81, s81, 15
s_lshl_b32 s82, s81, 7
s_mul_i32 s83, s81, 393216
s_add_u32 m0, s84, 40960
s_nop 0
buffer_load_dwordx4 v8, s[36:39], s82 offen  lds
s_add_u32 m0, m0, 0x400
s_nop 0
buffer_load_dwordx4 v9, s[36:39], s82 offen  lds
s_add_u32 m0, m0, 0x400
s_nop 0
buffer_load_dwordx4 v10, s[36:39], s82 offen  lds
s_add_u32 m0, m0, 0x400
s_nop 0
buffer_load_dwordx4 v11, s[36:39], s82 offen  lds
s_add_u32 m0, s85, 40960
s_nop 0
buffer_load_dwordx4 v12, s[68:71], s83 offen  lds
s_add_u32 m0, m0, 0x400
s_nop 0
buffer_load_dwordx4 v13, s[68:71], s83 offen  lds
s_add_u32 m0, m0, 0x400
s_nop 0
buffer_load_dwordx4 v14, s[68:71], s83 offen  lds
s_add_u32 m0, m0, 0x400
s_nop 0
buffer_load_dwordx4 v15, s[68:71], s83 offen  lds
s_add_u32 m0, m0, 0x400
s_nop 0
buffer_load_dwordx4 v16, s[68:71], s83 offen  lds
s_add_u32 m0, m0, 0x400
s_nop 0
buffer_load_dwordx4 v17, s[68:71], s83 offen  lds
s_waitcnt vmcnt(10)
s_barrier
s_add_u32 s81, s91, 8
s_and_b32 s81, s81, 15
s_lshl_b32 s82, s81, 7
s_mul_i32 s83, s81, 393216
s_add_u32 m0, s84, 81920
s_nop 0
buffer_load_dwordx4 v8, s[36:39], s82 offen  lds
s_add_u32 m0, m0, 0x400
s_nop 0
buffer_load_dwordx4 v9, s[36:39], s82 offen  lds
s_add_u32 m0, m0, 0x400
s_nop 0
buffer_load_dwordx4 v10, s[36:39], s82 offen  lds
s_add_u32 m0, m0, 0x400
s_nop 0
buffer_load_dwordx4 v11, s[36:39], s82 offen  lds
s_add_u32 m0, s85, 81920
s_nop 0
buffer_load_dwordx4 v12, s[68:71], s83 offen  lds
s_add_u32 m0, m0, 0x400
s_nop 0
buffer_load_dwordx4 v13, s[68:71], s83 offen  lds
s_add_u32 m0, m0, 0x400
s_nop 0
buffer_load_dwordx4 v14, s[68:71], s83 offen  lds
s_add_u32 m0, m0, 0x400
s_nop 0
buffer_load_dwordx4 v15, s[68:71], s83 offen  lds
s_add_u32 m0, m0, 0x400
s_nop 0
buffer_load_dwordx4 v16, s[68:71], s83 offen  lds
s_add_u32 m0, m0, 0x400
s_nop 0
buffer_load_dwordx4 v17, s[68:71], s83 offen  lds
s_waitcnt vmcnt(10)
s_barrier
s_add_u32 s81, s91, 9
s_and_b32 s81, s81, 15
s_lshl_b32 s82, s81, 7
s_mul_i32 s83, s81, 393216
s_add_u32 m0, s84, 0
s_nop 0
buffer_load_dwordx4 v8, s[36:39], s82 offen  lds
s_add_u32 m0, m0, 0x400
s_nop 0
buffer_load_dwordx4 v9, s[36:39], s82 offen  lds
s_add_u32 m0, m0, 0x400
s_nop 0
buffer_load_dwordx4 v10, s[36:39], s82 offen  lds
s_add_u32 m0, m0, 0x400
s_nop 0
buffer_load_dwordx4 v11, s[36:39], s82 offen  lds
s_add_u32 m0, s85, 0
s_nop 0
buffer_load_dwordx4 v12, s[68:71], s83 offen  lds
s_add_u32 m0, m0, 0x400
s_nop 0
buffer_load_dwordx4 v13, s[68:71], s83 offen  lds
s_add_u32 m0, m0, 0x400
s_nop 0
buffer_load_dwordx4 v14, s[68:71], s83 offen  lds
s_add_u32 m0, m0, 0x400
s_nop 0
buffer_load_dwordx4 v15, s[68:71], s83 offen  lds
s_add_u32 m0, m0, 0x400
s_nop 0
buffer_load_dwordx4 v16, s[68:71], s83 offen  lds
s_add_u32 m0, m0, 0x400
s_nop 0
buffer_load_dwordx4 v17, s[68:71], s83 offen  lds
s_waitcnt vmcnt(10)
s_barrier
s_add_u32 s81, s91, 10
s_and_b32 s81, s81, 15
s_lshl_b32 s82, s81, 7
s_mul_i32 s83, s81, 393216
s_add_u32 m0, s84, 40960
s_nop 0
buffer_load_dwordx4 v8, s[36:39], s82 offen  lds
s_add_u32 m0, m0, 0x400
s_nop 0
buffer_load_dwordx4 v9, s[36:39], s82 offen  lds
s_add_u32 m0, m0, 0x400
s_nop 0
buffer_load_dwordx4 v10, s[36:39], s82 offen  lds
s_add_u32 m0, m0, 0x400
s_nop 0
buffer_load_dwordx4 v11, s[36:39], s82 offen  lds
s_add_u32 m0, s85, 40960
s_nop 0
buffer_load_dwordx4 v12, s[68:71], s83 offen  lds
s_add_u32 m0, m0, 0x400
s_nop 0
buffer_load_dwordx4 v13, s[68:71], s83 offen  lds
s_add_u32 m0, m0, 0x400
s_nop 0
buffer_load_dwordx4 v14, s[68:71], s83 offen  lds
s_add_u32 m0, m0, 0x400
s_nop 0
buffer_load_dwordx4 v15, s[68:71], s83 offen  lds
s_add_u32 m0, m0, 0x400
s_nop 0
buffer_load_dwordx4 v16, s[68:71], s83 offen  lds
s_add_u32 m0, m0, 0x400
s_nop 0
buffer_load_dwordx4 v17, s[68:71], s83 offen  lds
s_waitcnt vmcnt(10)
s_barrier
s_add_u32 s81, s91, 11
s_and_b32 s81, s81, 15
s_lshl_b32 s82, s81, 7
s_mul_i32 s83, s81, 393216
s_add_u32 m0, s84, 81920
s_nop 0
buffer_load_dwordx4 v8, s[36:39], s82 offen  lds
s_add_u32 m0, m0, 0x400
s_nop 0
buffer_load_dwordx4 v9, s[36:39], s82 offen  lds
s_add_u32 m0, m0, 0x400
s_nop 0
buffer_load_dwordx4 v10, s[36:39], s82 offen  lds
s_add_u32 m0, m0, 0x400
s_nop 0
buffer_load_dwordx4 v11, s[36:39], s82 offen  lds
s_add_u32 m0, s85, 81920
s_nop 0
buffer_load_dwordx4 v12, s[68:71], s83 offen  lds
s_add_u32 m0, m0, 0x400
s_nop 0
buffer_load_dwordx4 v13, s[68:71], s83 offen  lds
s_add_u32 m0, m0, 0x400
s_nop 0
buffer_load_dwordx4 v14, s[68:71], s83 offen  lds
s_add_u32 m0, m0, 0x400
s_nop 0
buffer_load_dwordx4 v15, s[68:71], s83 offen  lds
s_add_u32 m0, m0, 0x400
s_nop 0
buffer_load_dwordx4 v16, s[68:71], s83 offen  lds
s_add_u32 m0, m0, 0x400
s_nop 0
buffer_load_dwordx4 v17, s[68:71], s83 offen  lds
s_waitcnt vmcnt(10)
s_barrier
s_add_u32 s81, s91, 12
s_and_b32 s81, s81, 15
s_lshl_b32 s82, s81, 7
s_mul_i32 s83, s81, 393216
s_add_u32 m0, s84, 0
s_nop 0
buffer_load_dwordx4 v8, s[36:39], s82 offen  lds
s_lshl_b32 s87, s74, 14
s_lshl_b32 s88, s80, 8
s_add_u32 m0, m0, 0x400
s_nop 0
buffer_load_dwordx4 v9, s[36:39], s82 offen  lds
s_add_u32 s87, s87, s88
s_add_u32 s87, s87, 12648448
s_add_u32 m0, m0, 0x400
s_nop 0
buffer_load_dwordx4 v10, s[36:39], s82 offen  lds
v_lshrrev_b32 v5, 4, v1
v_lshlrev_b32 v5, 10, v5
s_add_u32 m0, m0, 0x400
s_nop 0
buffer_load_dwordx4 v11, s[36:39], s82 offen  lds
v_and_b32 v6, 15, v1
v_lshl_add_u32 v5, v6, 4, v5
s_add_u32 m0, s85, 0
s_nop 0
buffer_load_dwordx4 v12, s[68:71], s83 offen  lds
v_add_u32 v30, s87, v5
s_lshl_b32 s87, s73, 11
s_add_u32 m0, m0, 0x400
s_nop 0
buffer_load_dwordx4 v13, s[68:71], s83 offen  lds
s_lshl_b32 s88, s80, 9
s_add_u32 s87, s87, s88
s_add_u32 m0, m0, 0x400
s_nop 0
buffer_load_dwordx4 v14, s[68:71], s83 offen  lds
s_add_u32 s87, s87, 12582912
v_and_b32 v6, 31, v1
s_add_u32 m0, m0, 0x400
s_nop 0
buffer_load_dwordx4 v15, s[68:71], s83 offen  lds
v_lshl_add_u32 v31, v6, 4, s87
s_mov_b32 s87, 0
buffer_load_dwordx4 v[40:43], v30, s[44:47], s87 offen sc1
s_add_u32 m0, m0, 0x400
s_nop 0
buffer_load_dwordx4 v16, s[68:71], s83 offen  lds
s_mov_b32 s87, 4096
buffer_load_dwordx4 v[44:47], v30, s[44:47], s87 offen sc1
s_mov_b32 s87, 8192
buffer_load_dwordx4 v[48:51], v30, s[44:47], s87 offen sc1
s_add_u32 m0, m0, 0x400
s_nop 0
buffer_load_dwordx4 v17, s[68:71], s83 offen  lds
s_mov_b32 s87, 12288
buffer_load_dwordx4 v[52:55], v30, s[44:47], s87 offen sc1
buffer_load_dwordx4 v[56:59], v31, s[44:47], 0 offen sc1
s_waitcnt vmcnt(15)
s_barrier
s_add_u32 s81, s91, 13
s_and_b32 s81, s81, 15
s_lshl_b32 s82, s81, 7
s_mul_i32 s83, s81, 393216
s_add_u32 m0, s84, 40960
s_nop 0
buffer_load_dwordx4 v8, s[36:39], s82 offen  lds
s_add_u32 m0, m0, 0x400
s_nop 0
buffer_load_dwordx4 v9, s[36:39], s82 offen  lds
s_add_u32 m0, m0, 0x400
s_nop 0
buffer_load_dwordx4 v10, s[36:39], s82 offen  lds
s_add_u32 m0, m0, 0x400
s_nop 0
buffer_load_dwordx4 v11, s[36:39], s82 offen  lds
s_add_u32 m0, s85, 40960
s_nop 0
buffer_load_dwordx4 v12, s[68:71], s83 offen  lds
s_add_u32 m0, m0, 0x400
s_nop 0
buffer_load_dwordx4 v13, s[68:71], s83 offen  lds
s_add_u32 m0, m0, 0x400
s_nop 0
buffer_load_dwordx4 v14, s[68:71], s83 offen  lds
s_add_u32 m0, m0, 0x400
s_nop 0
buffer_load_dwordx4 v15, s[68:71], s83 offen  lds
s_add_u32 m0, m0, 0x400
s_nop 0
buffer_load_dwordx4 v16, s[68:71], s83 offen  lds
s_add_u32 m0, m0, 0x400
s_nop 0
buffer_load_dwordx4 v17, s[68:71], s83 offen  lds
s_waitcnt vmcnt(12)
s_barrier
s_waitcnt vmcnt(10)
L_gretry_1:
v_cmp_ne_u32 vcc, s77, v43
v_cmp_ne_u32 s[88:89], s77, v47
s_nop 1
s_or_b64 vcc, vcc, s[88:89]
v_cmp_ne_u32 s[88:89], s77, v51
s_nop 1
s_or_b64 vcc, vcc, s[88:89]
v_cmp_ne_u32 s[88:89], s77, v55
s_nop 1
s_or_b64 vcc, vcc, s[88:89]
v_cmp_ne_u32 s[88:89], s77, v58
s_nop 1
s_or_b64 vcc, vcc, s[88:89]
s_cbranch_vccz L_gok_2
s_add_u32 s90, s90, 1
s_cmp_gt_u32 s90, 200000
s_cbranch_scc1 L_gok_2
s_sleep 2
s_mov_b32 s87, 0
buffer_load_dwordx4 v[40:43], v30, s[44:47], s87 offen sc1
s_mov_b32 s87, 4096
buffer_load_dwordx4 v[44:47], v30, s[44:47], s87 offen sc1
s_mov_b32 s87, 8192
buffer_load_dwordx4 v[48:51], v30, s[44:47], s87 offen sc1
s_mov_b32 s87, 12288
buffer_load_dwordx4 v[52:55], v30, s[44:47], s87 offen sc1
buffer_load_dwordx4 v[56:59], v31, s[44:47], 0 offen sc1
s_waitcnt vmcnt(0)
s_branch L_gretry_1
L_gok_2:
s_add_u32 s81, s91, 14
s_and_b32 s81, s81, 15
s_lshl_b32 s82, s81, 7
s_mul_i32 s83, s81, 393216
s_add_u32 m0, s84, 81920
s_nop 0
buffer_load_dwordx4 v8, s[36:39], s82 offen  lds
v_add_f32 v40, v40, v44
v_add_f32 v40, v40, v48
s_add_u32 m0, m0, 0x400
s_nop 0
buffer_load_dwordx4 v9, s[36:39], s82 offen  lds
v_add_f32 v40, v40, v52
v_add_f32 v41, v41, v45
s_add_u32 m0, m0, 0x400
s_nop 0
buffer_load_dwordx4 v10, s[36:39], s82 offen  lds
v_add_f32 v41, v41, v49
v_add_f32 v41, v41, v53
s_add_u32 m0, m0, 0x400
s_nop 0
buffer_load_dwordx4 v11, s[36:39], s82 offen  lds
v_add_f32 v42, v42, v46
v_add_f32 v42, v42, v50
s_add_u32 m0, s85, 81920
s_nop 0
buffer_load_dwordx4 v12, s[68:71], s83 offen  lds
v_add_f32 v42, v42, v54
v_mov_b32 v44, v40
s_add_u32 m0, m0, 0x400
s_nop 0
buffer_load_dwordx4 v13, s[68:71], s83 offen  lds
v_permlane16_swap_b32 v40, v44
v_add_f32 v40, v40, v44
s_add_u32 m0, m0, 0x400
s_nop 0
buffer_load_dwordx4 v14, s[68:71], s83 offen  lds
v_mov_b32 v45, v41
s_nop 1
v_permlane16_swap_b32 v41, v45
s_add_u32 m0, m0, 0x400
s_nop 0
buffer_load_dwordx4 v15, s[68:71], s83 offen  lds
v_add_f32 v41, v41, v45
v_mov_b32 v46, v42
s_add_u32 m0, m0, 0x400
s_nop 0
buffer_load_dwordx4 v16, s[68:71], s83 offen  lds
v_permlane16_swap_b32 v42, v46
v_add_f32 v42, v42, v46
s_add_u32 m0, m0, 0x400
s_nop 0
buffer_load_dwordx4 v17, s[68:71], s83 offen  lds
v_mov_b32 v44, v40
s_nop 1
v_permlane32_swap_b32 v40, v44
s_waitcnt vmcnt(10)
s_barrier
s_add_u32 s81, s91, 15
s_and_b32 s81, s81, 15
s_lshl_b32 s82, s81, 7
s_mul_i32 s83, s81, 393216
s_add_u32 m0, s84, 0
s_nop 0
buffer_load_dwordx4 v8, s[36:39], s82 offen  lds
v_add_f32 v40, v40, v44
v_mov_b32 v45, v41
s_add_u32 m0, m0, 0x400
s_nop 0
buffer_load_dwordx4 v9, s[36:39], s82 offen  lds
v_permlane32_swap_b32 v41, v45
v_add_f32 v41, v41, v45
s_add_u32 m0, m0, 0x400
s_nop 0
buffer_load_dwordx4 v10, s[36:39], s82 offen  lds
v_mov_b32 v46, v42
s_nop 1
v_permlane32_swap_b32 v42, v46
s_add_u32 m0, m0, 0x400
s_nop 0
buffer_load_dwordx4 v11, s[36:39], s82 offen  lds
v_add_f32 v42, v42, v46
s_lshl_b32 s87, s80, 6
s_add_u32 m0, s85, 0
s_nop 0
buffer_load_dwordx4 v12, s[68:71], s83 offen  lds
s_add_u32 s87, s87, 123904
v_and_b32 v5, 15, v1
s_add_u32 m0, m0, 0x400
s_nop 0
buffer_load_dwordx4 v13, s[68:71], s83 offen  lds
v_lshl_add_u32 v5, v5, 2, s87
ds_write_b32 v5, v40 offset:0
s_add_u32 m0, m0, 0x400
s_nop 0
buffer_load_dwordx4 v14, s[68:71], s83 offen  lds
ds_write_b32 v5, v41 offset:256
ds_write_b32 v5, v42 offset:512
s_add_u32 m0, m0, 0x400
s_nop 0
buffer_load_dwordx4 v15, s[68:71], s83 offen  lds
s_lshl_b32 s87, s80, 7
s_add_u32 s87, s87, 122880
s_add_u32 m0, m0, 0x400
s_nop 0
buffer_load_dwordx4 v16, s[68:71], s83 offen  lds
v_and_b32 v5, 31, v1
v_lshl_add_u32 v5, v5, 2, s87
s_add_u32 m0, m0, 0x400
s_nop 0
buffer_load_dwordx4 v17, s[68:71], s83 offen  lds
ds_write_b32 v5, v56
ds_write_b32 v5, v57 offset:512
s_waitcnt vmcnt(10)
s_waitcnt lgkmcnt(0)
s_barrier
s_waitcnt vmcnt(0)
s_barrier
s_waitcnt lgkmcnt(0)
s_barrier
s_and_b32 s91, s72, 3
s_min_u32 s87, s79, 223
s_lshr_b32 s86, s87, 2
s_and_b32 s87, s87, 3
v_lshrrev_b32 v5, 3, v1
v_and_b32 v6, 7, v1
s_lshl_b32 s88, s87, 8
s_lshl_b32 s89, s91, 6
s_add_u32 s88, s88, s89
v_add_u32 v7, s88, v5
s_mov_b32 s88, 7168
v_mul_lo_u32 v7, v7, s88
s_lshl_b32 s88, s86, 7
v_add_u32 v7, s88, v7
v_bfe_u32 v5, v5, 1, 1
v_lshlrev_b32 v5, 2, v5
v_xor_b32 v5, v5, v6
v_lshl_add_u32 v113, v5, 4, v7
v_xor_b32 v5, 2, v5
v_lshl_add_u32 v114, v5, 4, v7
s_lshl_b32 s88, s86, 6
s_lshl_b32 s89, s91, 4
s_add_u32 s88, s88, s89
v_lshrrev_b32 v6, 5, v1
v_add_u32 v6, s88, v6
v_lshlrev_b32 v6, 11, v6
s_lshl_b32 s88, s87, 9
v_and_b32 v7, 31, v1
v_lshl_add_u32 v6, v7, 4, v6
v_add_u32 v115, s88, v6
s_mov_b32 s88, 0
buffer_load_dwordx4 v[160:163], v113, s[52:55], s88 offen
s_mov_b32 s88, 57344
buffer_load_dwordx4 v[164:167], v114, s[52:55], s88 offen
s_mov_b32 s88, 114688
buffer_load_dwordx4 v[168:171], v113, s[52:55], s88 offen
s_mov_b32 s88, 172032
buffer_load_dwordx4 v[172:175], v114, s[52:55], s88 offen
s_mov_b32 s88, 229376
buffer_load_dwordx4 v[176:179], v113, s[52:55], s88 offen
s_mov_b32 s88, 286720
buffer_load_dwordx4 v[180:183], v114, s[52:55], s88 offen
s_mov_b32 s88, 344064
buffer_load_dwordx4 v[184:187], v113, s[52:55], s88 offen
s_mov_b32 s88, 401408
buffer_load_dwordx4 v[188:191], v114, s[52:55], s88 offen
s_mov_b32 s4, 0xffffffff
s_mov_b32 s5, 0xfffffff0
s_mov_b32 s6, 0xfffffffe
s_mov_b32 s7, 0xffffffe0
s_mov_b32 s8, 0xfffffffc
s_mov_b32 s9, 0xffffffc0
s_mov_b32 s10, 0xfffffff8
s_mov_b32 s11, 0xffffff80
s_mov_b32 s12, 0xffff0000
s_mov_b32 s13, 0xfff00000
s_mov_b32 s14, 0xfffe0000
s_mov_b32 s15, 0xffe00000
s_mov_b32 s16, 0xfffc0000
s_mov_b32 s17, 0xffc00000
s_mov_b32 s18, 0xfff80000
s_mov_b32 s19, 0xff800000
s_mov_b32 s20, 0xffffff00
s_mov_b32 s21, 0xfffff000
s_mov_b32 s22, 0xfffffe00
s_mov_b32 s23, 0xffffe000
s_mov_b32 s24, 0xfffffc00
s_mov_b32 s25, 0xffffc000
s_mov_b32 s26, 0xfffff800
s_mov_b32 s27, 0xffff8000
s_mov_b32 s28, 0xff000000
s_mov_b32 s29, 0xf0000000
s_mov_b32 s30, 0xfe000000
s_mov_b32 s31, 0xe0000000
s_mov_b32 s32, 0xfc000000
s_mov_b32 s33, 0xc0000000
s_mov_b32 s34, 0xf8000000
s_mov_b32 s35, 0x80000000
L_p1_join:
s_setprio 0
s_cmp_lt_u32 s72, 4
s_cbranch_scc1 L_prio_3
s_setprio 1
L_prio_3:
s_barrier
s_and_b32 s81, s72, 1
s_lshr_b32 s86, s72, 1
s_sub_u32 s87, 5, s86
s_sub_u32 s87, 3, s86
s_sub_u32 s86, s86, 2
s_cmp_lt_u32 s72, 4
s_cselect_b32 s80, s87, s86
s_lshl_b32 s85, s74, 1
s_add_u32 s85, s85, s81
s_mov_b32 s82, 0
s_cmp_lt_u32 s72, 4
s_cbranch_scc1 L_nowo1_4
v_lshrrev_b32 v2, 3, v1
v_and_b32 v4, 7, v1
v_bfe_u32 v5, v2, 1, 2
v_lshlrev_b32 v5, 1, v5
v_xor_b32 v5, v5, v4
s_mul_i32 s86, s72, 12
s_sub_u32 s86, s86, 48
s_lshl_b32 s87, s86, 3
v_add_u32 v6, s87, v2
v_lshlrev_b32 v6, 11, v6
s_lshl_b32 s87, s76, 7
v_lshl_add_u32 v6, v5, 4, v6
v_add_u32 v6, s87, v6
s_lshl_b32 s86, s86, 10
s_add_u32 m0, s86, 98304
s_mov_b32 s87, 0
buffer_load_dwordx4 v6, s[40:43], s87 offen lds
s_add_u32 m0, m0, 0x400
s_mov_b32 s87, 16384
buffer_load_dwordx4 v6, s[40:43], s87 offen lds
s_add_u32 m0, m0, 0x400
s_mov_b32 s87, 32768
buffer_load_dwordx4 v6, s[40:43], s87 offen lds
s_add_u32 m0, m0, 0x400
s_mov_b32 s87, 49152
buffer_load_dwordx4 v6, s[40:43], s87 offen lds
s_add_u32 m0, m0, 0x400
s_mov_b32 s87, 65536
buffer_load_dwordx4 v6, s[40:43], s87 offen lds
s_add_u32 m0, m0, 0x400
s_mov_b32 s87, 81920
buffer_load_dwordx4 v6, s[40:43], s87 offen lds
s_add_u32 m0, m0, 0x400
s_mov_b32 s87, 98304
buffer_load_dwordx4 v6, s[40:43], s87 offen lds
s_add_u32 m0, m0, 0x400
s_mov_b32 s87, 114688
buffer_load_dwordx4 v6, s[40:43], s87 offen lds
s_add_u32 m0, m0, 0x400
s_mov_b32 s87, 131072
buffer_load_dwordx4 v6, s[40:43], s87 offen lds
s_add_u32 m0, m0, 0x400
s_mov_b32 s87, 147456
buffer_load_dwordx4 v6, s[40:43], s87 offen lds
s_add_u32 m0, m0, 0x400
s_mov_b32 s87, 163840
buffer_load_dwordx4 v6, s[40:43], s87 offen lds
s_add_u32 m0, m0, 0x400
s_mov_b32 s87, 180224
buffer_load_dwordx4 v6, s[40:43], s87 offen lds
L_nowo1_4:
s_lshl_b32 s86, s81, 13
s_lshl_b32 s87, s80, 11
s_add_u32 s86, s86, s87
s_add_u32 s86, s86, 147456
v_lshl_add_u32 v110, v1, 4, s86
ds_read_b128 v[8:11], v110
ds_read_b128 v[12:15], v110 offset:1024
s_mul_i32 s86, s81, 49152
v_lshl_add_u32 v111, v1, 4, s86
v_mov_b32 v104, 0x3f803f80
v_mov_b32 v105, 0x3f803f80
v_mov_b32 v106, 0x3f803f80
v_mov_b32 v107, 0x3f803f80
v_mov_b32 v112, 0xff800000
L_att_start:
s_add_u32 s83, s80, 8
s_lshl_b32 s86, s83, 12
v_add_u32 v108, s86, v111
ds_read_b128 v[16:19], v108 offset:0
ds_read_b128 v[20:23], v108 offset:1024
ds_read_b128 v[24:27], v108 offset:2048
ds_read_b128 v[28:31], v108 offset:3072
s_waitcnt lgkmcnt(2)
v_mfma_f32_32x32x16_bf16 v[32:47], v[16:19], v[8:11], 0
v_mfma_f32_32x32x16_bf16 v[32:47], v[20:23], v[12:15], v[32:47]
s_nop 11
v_cndmask_b32 v32, v112, v32, s[4:5]
v_cndmask_b32 v33, v112, v33, s[6:7]
v_cndmask_b32 v34, v112, v34, s[8:9]
v_cndmask_b32 v35, v112, v35, s[10:11]
v_cndmask_b32 v36, v112, v36, s[12:13]
v_cndmask_b32 v37, v112, v37, s[14:15]
v_cndmask_b32 v38, v112, v38, s[16:17]
v_cndmask_b32 v39, v112, v39, s[18:19]
v_cndmask_b32 v40, v112, v40, s[20:21]
v_cndmask_b32 v41, v112, v41, s[22:23]
v_cndmask_b32 v42, v112, v42, s[24:25]
v_cndmask_b32 v43, v112, v43, s[26:27]
v_cndmask_b32 v44, v112, v44, s[28:29]
v_cndmask_b32 v45, v112, v45, s[30:31]
v_cndmask_b32 v46, v112, v46, s[32:33]
v_cndmask_b32 v47, v112, v47, s[34:35]
s_cmp_lg_u32 s82, 0
s_cbranch_scc1 L_havemax_5
v_max3_f32 v109, v32, v33, v34
v_max3_f32 v110, v35, v36, v37
v_max3_f32 v109, v109, v38, v39
v_max3_f32 v110, v110, v40, v41
v_max3_f32 v109, v109, v42, v43
v_max3_f32 v110, v110, v44, v45
v_max3_f32 v109, v109, v46, v47
v_max_f32 v109, v109, v110
v_mov_b32 v110, v109
s_nop 1
v_permlane32_swap_b32 v109, v110
v_max_f32 v109, v109, v110
L_havemax_5:
v_sub_f32 v88, 0, v109
v_sub_f32 v89, 0, v109
v_pk_add_f32 v[32:33], v[32:33], v[88:89]
v_pk_add_f32 v[34:35], v[34:35], v[88:89]
v_pk_add_f32 v[36:37], v[36:37], v[88:89]
v_pk_add_f32 v[38:39], v[38:39], v[88:89]
v_pk_add_f32 v[40:41], v[40:41], v[88:89]
v_pk_add_f32 v[42:43], v[42:43], v[88:89]
v_pk_add_f32 v[44:45], v[44:45], v[88:89]
v_pk_add_f32 v[46:47], v[46:47], v[88:89]
v_mov_b64 v[90:91], v[88:89]
v_mov_b64 v[92:93], v[88:89]
v_mov_b64 v[94:95], v[88:89]
v_mov_b64 v[96:97], v[88:89]
v_mov_b64 v[98:99], v[88:89]
v_mov_b64 v[100:101], v[88:89]
v_mov_b64 v[102:103], v[88:89]
v_exp_f32 v32, v32
v_exp_f32 v33, v33
v_exp_f32 v34, v34
v_exp_f32 v35, v35
v_cvt_pk_bf16_f32 v48, v32, v33
v_exp_f32 v36, v36
v_exp_f32 v37, v37
v_cvt_pk_bf16_f32 v49, v34, v35
v_exp_f32 v38, v38
v_exp_f32 v39, v39
v_cvt_pk_bf16_f32 v50, v36, v37
v_exp_f32 v40, v40
v_exp_f32 v41, v41
v_cvt_pk_bf16_f32 v51, v38, v39
v_exp_f32 v42, v42
v_exp_f32 v43, v43
v_cvt_pk_bf16_f32 v52, v40, v41
v_exp_f32 v44, v44
v_exp_f32 v45, v45
v_cvt_pk_bf16_f32 v53, v42, v43
v_exp_f32 v46, v46
v_exp_f32 v47, v47
v_cvt_pk_bf16_f32 v54, v44, v45
v_cvt_pk_bf16_f32 v55, v46, v47
s_waitcnt lgkmcnt(0)
v_mfma_f32_32x32x16_bf16 v[56:71], v[24:27], v[48:51], 0
v_mfma_f32_32x32x16_bf16 v[72:87], v[104:107], v[48:51], 0
v_mfma_f32_32x32x16_bf16 v[56:71], v[28:31], v[52:55], v[56:71]
v_mfma_f32_32x32x16_bf16 v[72:87], v[104:107], v[52:55], v[72:87]
s_cmp_ge_u32 s72, 4
s_cbranch_scc1 L_noflag_6
s_cmp_lg_u32 s82, 0
s_cbranch_scc1 L_noflag_6
s_waitcnt vmcnt(0)
s_lshl_b32 s86, s73, 4
s_add_u32 s86, s86, s74
s_lshl_b32 s86, s86, 6
s_lshl_b32 s87, s72, 2
s_add_u32 s86, s86, s87
s_add_u32 s86, s86, 12976128
v_mov_b32 v110, s86
v_mov_b32 v2, s77
v_cmp_eq_u32 vcc, 0, v1
s_nop 1
s_and_saveexec_b64 s[96:97], vcc
buffer_store_dword v2, v110, s[44:47], 0 offen sc1
s_mov_b64 exec, s[96:97]
L_noflag_6:
s_cmp_eq_u32 s80, 0
s_cbranch_scc1 L_nolocal_7
s_mov_b32 s83, 8
s_add_u32 s84, s80, 8
s_lshl_b32 s86, s83, 12
v_add_u32 v108, s86, v111
ds_read_b128 v[16:19], v108 offset:0
ds_read_b128 v[20:23], v108 offset:1024
v_mov_b64 v[48:49], 0
v_mov_b64 v[50:51], 0
v_mov_b64 v[52:53], 0
v_mov_b64 v[54:55], 0
s_waitcnt lgkmcnt(0)
v_mfma_f32_32x32x16_bf16 v[32:47], v[16:19], v[8:11], v[88:103]
v_mfma_f32_32x32x16_bf16 v[32:47], v[20:23], v[12:15], v[32:47]
s_nop 7
L_att_local:
s_waitcnt lgkmcnt(0)
ds_read_b128 v[16:19], v108 offset:4096
ds_read_b128 v[20:23], v108 offset:5120
v_mfma_f32_32x32x16_bf16 v[56:71], v[24:27], v[48:51], v[56:71]
v_exp_f32 v128, v32
v_exp_f32 v129, v33
v_exp_f32 v130, v34
v_exp_f32 v131, v35
v_mfma_f32_32x32x16_bf16 v[72:87], v[104:107], v[48:51], v[72:87]
v_exp_f32 v132, v36
v_exp_f32 v133, v37
v_exp_f32 v134, v38
v_exp_f32 v135, v39
v_mfma_f32_32x32x16_bf16 v[56:71], v[28:31], v[52:55], v[56:71]
v_exp_f32 v136, v40
v_exp_f32 v137, v41
v_exp_f32 v138, v42
v_exp_f32 v139, v43
v_mfma_f32_32x32x16_bf16 v[72:87], v[104:107], v[52:55], v[72:87]
v_exp_f32 v140, v44
v_exp_f32 v141, v45
v_exp_f32 v142, v46
v_exp_f32 v143, v47
ds_read_b128 v[24:27], v108 offset:2048
ds_read_b128 v[28:31], v108 offset:3072
s_waitcnt lgkmcnt(2)
v_mfma_f32_32x32x16_bf16 v[32:47], v[16:19], v[8:11], v[88:103]
v_cvt_pk_bf16_f32 v48, v128, v129
v_cvt_pk_bf16_f32 v49, v130, v131
v_cvt_pk_bf16_f32 v50, v132, v133
v_cvt_pk_bf16_f32 v51, v134, v135
v_mfma_f32_32x32x16_bf16 v[32:47], v[20:23], v[12:15], v[32:47]
v_cvt_pk_bf16_f32 v52, v136, v137
v_cvt_pk_bf16_f32 v53, v138, v139
v_cvt_pk_bf16_f32 v54, v140, v141
v_cvt_pk_bf16_f32 v55, v142, v143
v_add_u32 v108, 4096, v108
s_add_u32 s83, s83, 1
s_cmp_lt_u32 s83, s84
s_cbranch_scc1 L_att_local
s_waitcnt lgkmcnt(0)
v_mfma_f32_32x32x16_bf16 v[56:71], v[24:27], v[48:51], v[56:71]
v_mfma_f32_32x32x16_bf16 v[72:87], v[104:107], v[48:51], v[72:87]
v_mfma_f32_32x32x16_bf16 v[56:71], v[28:31], v[52:55], v[56:71]
v_mfma_f32_32x32x16_bf16 v[72:87], v[104:107], v[52:55], v[72:87]
L_nolocal_7:
s_lshl_b32 s86, s73, 3
s_lshl_b32 s87, s80, 1
s_add_u32 s86, s86, s87
s_lshl_b32 s86, s86, 5
s_add_u32 s86, s86, s85
s_lshl_b32 s86, s86, 10
s_add_u32 s86, s86, 8388608
v_bfe_u32 v2, v1, 4, 1
v_lshlrev_b32 v2, 15, v2
v_lshrrev_b32 v4, 5, v1
v_lshlrev_b32 v4, 8, v4
v_add_u32 v2, v2, v4
v_and_b32 v4, 15, v1
v_lshl_add_u32 v2, v4, 4, v2
v_add_u32 v116, s86, v2
s_lshl_b32 s86, s73, 2
s_add_u32 s86, s86, s80
s_lshl_b32 s86, s86, 7
s_lshl_b32 s87, s85, 2
s_add_u32 s86, s86, s87
s_add_u32 s86, s86, 13041664
v_mov_b32 v117, s86
s_cmp_lg_u32 s82, 0
s_cbranch_scc1 L_remdone_8
s_lshr_b32 s86, s72, 2
s_add_u32 s87, s73, s86
s_cmp_lt_u32 s87, 2
s_cbranch_scc1 L_nodma_9
s_sub_u32 s87, s87, 2
s_lshl_b32 s87, s87, 4
s_add_u32 s87, s87, s74
s_and_b32 s88, s72, 3
s_lshl_b32 s89, s87, 6
s_lshl_b32 s91, s88, 2
s_add_u32 s89, s89, s91
s_add_u32 s89, s89, 12976128
s_mov_b32 s90, 0
L_kvpoll_10:
s_load_dword s93, s[44:45], s89 glc
s_waitcnt lgkmcnt(0)
s_cmp_eq_u32 s93, s77
s_cbranch_scc1 L_kvok_11
s_add_u32 s90, s90, 1
s_cmp_gt_u32 s90, 200000
s_cbranch_scc1 L_kvok_11
s_branch L_kvpoll_10
L_kvok_11:
s_and_b32 s91, s88, 1
s_lshr_b32 s92, s88, 1
s_lshl_b32 s87, s87, 15
s_lshl_b32 s93, s91, 14
s_add_u32 s87, s87, s93
s_lshl_b32 s93, s92, 13
s_add_u32 s87, s87, s93
s_add_u32 s87, s87, 0
s_mul_i32 s91, s91, 49152
s_lshl_b32 s86, s86, 14
s_add_u32 s91, s91, s86
s_add_u32 s91, s91, s93
v_lshlrev_b32 v2, 4, v1
s_mov_b32 m0, s91
s_nop 0
buffer_load_dwordx4 v2, s[44:47], s87 offen sc1 lds
s_add_u32 m0, m0, 0x400
s_add_u32 s87, s87, 0x400
buffer_load_dwordx4 v2, s[44:47], s87 offen sc1 lds
s_add_u32 m0, m0, 0x400
s_add_u32 s87, s87, 0x400
buffer_load_dwordx4 v2, s[44:47], s87 offen sc1 lds
s_add_u32 m0, m0, 0x400
s_add_u32 s87, s87, 0x400
buffer_load_dwordx4 v2, s[44:47], s87 offen sc1 lds
s_add_u32 m0, m0, 0x400
s_add_u32 s87, s87, 0x400
buffer_load_dwordx4 v2, s[44:47], s87 offen sc1 lds
s_add_u32 m0, m0, 0x400
s_add_u32 s87, s87, 0x400
buffer_load_dwordx4 v2, s[44:47], s87 offen sc1 lds
s_add_u32 m0, m0, 0x400
s_add_u32 s87, s87, 0x400
buffer_load_dwordx4 v2, s[44:47], s87 offen sc1 lds
s_add_u32 m0, m0, 0x400
s_add_u32 s87, s87, 0x400
buffer_load_dwordx4 v2, s[44:47], s87 offen sc1 lds
s_waitcnt vmcnt(0)
L_nodma_9:
s_waitcnt vmcnt(0)
s_barrier
v_lshrrev_b32 v2, 3, v1
v_and_b32 v4, 7, v1
v_bfe_u32 v5, v2, 1, 2
v_lshlrev_b32 v5, 1, v5
v_xor_b32 v5, v5, v4
s_mul_i32 s86, s72, 2
s_add_u32 s86, s86, 48
s_lshl_b32 s87, s86, 3
v_add_u32 v6, s87, v2
v_lshlrev_b32 v6, 11, v6
s_lshl_b32 s87, s76, 7
v_lshl_add_u32 v6, v5, 4, v6
v_add_u32 v6, s87, v6
s_lshl_b32 s86, s86, 10
s_add_u32 m0, s86, 98304
s_mov_b32 s87, 0
buffer_load_dwordx4 v6, s[40:43], s87 offen lds
s_add_u32 m0, m0, 0x400
s_mov_b32 s87, 16384
buffer_load_dwordx4 v6, s[40:43], s87 offen lds
s_cmp_ge_u32 s72, 4
s_cbranch_scc1 L_noffn1_12
s_and_b32 s91, s72, 3
s_min_u32 s87, s79, 223
s_lshr_b32 s86, s87, 2
s_and_b32 s87, s87, 3
v_lshrrev_b32 v5, 3, v1
v_and_b32 v6, 7, v1
s_lshl_b32 s88, s87, 8
s_lshl_b32 s89, s91, 6
s_add_u32 s88, s88, s89
v_add_u32 v7, s88, v5
s_mov_b32 s88, 7168
v_mul_lo_u32 v7, v7, s88
s_lshl_b32 s88, s86, 7
v_add_u32 v7, s88, v7
v_bfe_u32 v5, v5, 1, 1
v_lshlrev_b32 v5, 2, v5
v_xor_b32 v5, v5, v6
v_lshl_add_u32 v113, v5, 4, v7
v_xor_b32 v5, 2, v5
v_lshl_add_u32 v114, v5, 4, v7
s_lshl_b32 s88, s86, 6
s_lshl_b32 s89, s91, 4
s_add_u32 s88, s88, s89
v_lshrrev_b32 v6, 5, v1
v_add_u32 v6, s88, v6
v_lshlrev_b32 v6, 11, v6
s_lshl_b32 s88, s87, 9
v_and_b32 v7, 31, v1
v_lshl_add_u32 v6, v7, 4, v6
v_add_u32 v115, s88, v6
s_mov_b32 s88, 0
buffer_load_dwordx4 v[160:163], v113, s[56:59], s88 offen
s_mov_b32 s88, 57344
buffer_load_dwordx4 v[164:167], v114, s[56:59], s88 offen
s_mov_b32 s88, 114688
buffer_load_dwordx4 v[168:171], v113, s[56:59], s88 offen
s_mov_b32 s88, 172032
buffer_load_dwordx4 v[172:175], v114, s[56:59], s88 offen
s_mov_b32 s88, 229376
buffer_load_dwordx4 v[176:179], v113, s[56:59], s88 offen
s_mov_b32 s88, 286720
buffer_load_dwordx4 v[180:183], v114, s[56:59], s88 offen
s_mov_b32 s88, 344064
buffer_load_dwordx4 v[184:187], v113, s[56:59], s88 offen
s_mov_b32 s88, 401408
buffer_load_dwordx4 v[188:191], v114, s[56:59], s88 offen
s_mov_b32 s88, 0
buffer_load_dwordx4 v[192:195], v115, s[60:63], s88 offen
s_mov_b32 s88, 4096
buffer_load_dwordx4 v[196:199], v115, s[60:63], s88 offen
s_mov_b32 s88, 8192
buffer_load_dwordx4 v[200:203], v115, s[60:63], s88 offen
s_mov_b32 s88, 12288
buffer_load_dwordx4 v[204:207], v115, s[60:63], s88 offen
s_mov_b32 s88, 16384
buffer_load_dwordx4 v[208:211], v115, s[60:63], s88 offen
s_mov_b32 s88, 20480
buffer_load_dwordx4 v[212:215], v115, s[60:63], s88 offen
s_mov_b32 s88, 24576
buffer_load_dwordx4 v[216:219], v115, s[60:63], s88 offen
s_mov_b32 s88, 28672
buffer_load_dwordx4 v[220:223], v115, s[60:63], s88 offen
L_noffn1_12:
L_remdone_8:
s_cmp_eq_u32 s73, 0
s_cbranch_scc1 L_remend_15
s_cmp_eq_u32 s73, 1
s_cbranch_scc1 L_nofirst_13
s_lshl_b32 s86, s80, 12
v_add_u32 v108, s86, v111
ds_read_b128 v[16:19], v108 offset:0
ds_read_b128 v[20:23], v108 offset:1024
ds_read_b128 v[24:27], v108 offset:2048
ds_read_b128 v[28:31], v108 offset:3072
s_waitcnt lgkmcnt(2)
v_mfma_f32_32x32x16_bf16 v[32:47], v[16:19], v[8:11], v[88:103]
v_mfma_f32_32x32x16_bf16 v[32:47], v[20:23], v[12:15], v[32:47]
s_nop 11
v_cndmask_b32 v32, v32, v112, s[4:5]
v_cndmask_b32 v33, v33, v112, s[6:7]
v_cndmask_b32 v34, v34, v112, s[8:9]
v_cndmask_b32 v35, v35, v112, s[10:11]
v_cndmask_b32 v36, v36, v112, s[12:13]
v_cndmask_b32 v37, v37, v112, s[14:15]
v_cndmask_b32 v38, v38, v112, s[16:17]
v_cndmask_b32 v39, v39, v112, s[18:19]
v_cndmask_b32 v40, v40, v112, s[20:21]
v_cndmask_b32 v41, v41, v112, s[22:23]
v_cndmask_b32 v42, v42, v112, s[24:25]
v_cndmask_b32 v43, v43, v112, s[26:27]
v_cndmask_b32 v44, v44, v112, s[28:29]
v_cndmask_b32 v45, v45, v112, s[30:31]
v_cndmask_b32 v46, v46, v112, s[32:33]
v_cndmask_b32 v47, v47, v112, s[34:35]
v_exp_f32 v32, v32
v_exp_f32 v33, v33
v_exp_f32 v34, v34
v_exp_f32 v35, v35
v_cvt_pk_bf16_f32 v48, v32, v33
v_exp_f32 v36, v36
v_exp_f32 v37, v37
v_cvt_pk_bf16_f32 v49, v34, v35
v_exp_f32 v38, v38
v_exp_f32 v39, v39
v_cvt_pk_bf16_f32 v50, v36, v37
v_exp_f32 v40, v40
v_exp_f32 v41, v41
v_cvt_pk_bf16_f32 v51, v38, v39
v_exp_f32 v42, v42
v_exp_f32 v43, v43
v_cvt_pk_bf16_f32 v52, v40, v41
v_exp_f32 v44, v44
v_exp_f32 v45, v45
v_cvt_pk_bf16_f32 v53, v42, v43
v_exp_f32 v46, v46
v_exp_f32 v47, v47
v_cvt_pk_bf16_f32 v54, v44, v45
v_cvt_pk_bf16_f32 v55, v46, v47
s_waitcnt lgkmcnt(0)
v_mfma_f32_32x32x16_bf16 v[56:71], v[24:27], v[48:51], v[56:71]
v_mfma_f32_32x32x16_bf16 v[72:87], v[104:107], v[48:51], v[72:87]
v_mfma_f32_32x32x16_bf16 v[56:71], v[28:31], v[52:55], v[56:71]
v_mfma_f32_32x32x16_bf16 v[72:87], v[104:107], v[52:55], v[72:87]
s_add_u32 s83, s80, 1
s_max_u32 s83, s83, 1
s_cmp_ge_u32 s83, 8
s_cbranch_scc1 L_remend_15
s_branch L_remloop_14
L_nofirst_13:
s_mov_b32 s83, 4
L_remloop_14:
s_lshl_b32 s86, s83, 12
v_add_u32 v108, s86, v111
s_mov_b32 s84, 8
ds_read_b128 v[16:19], v108 offset:0
ds_read_b128 v[20:23], v108 offset:1024
v_mov_b64 v[48:49], 0
v_mov_b64 v[50:51], 0
v_mov_b64 v[52:53], 0
v_mov_b64 v[54:55], 0
s_waitcnt lgkmcnt(0)
v_mfma_f32_32x32x16_bf16 v[32:47], v[16:19], v[8:11], v[88:103]
v_mfma_f32_32x32x16_bf16 v[32:47], v[20:23], v[12:15], v[32:47]
s_nop 7
L_att_remote:
s_waitcnt lgkmcnt(0)
ds_read_b128 v[16:19], v108 offset:4096
ds_read_b128 v[20:23], v108 offset:5120
v_mfma_f32_32x32x16_bf16 v[56:71], v[24:27], v[48:51], v[56:71]
v_exp_f32 v128, v32
v_exp_f32 v129, v33
v_exp_f32 v130, v34
v_exp_f32 v131, v35
v_mfma_f32_32x32x16_bf16 v[72:87], v[104:107], v[48:51], v[72:87]
v_exp_f32 v132, v36
v_exp_f32 v133, v37
v_exp_f32 v134, v38
v_exp_f32 v135, v39
v_mfma_f32_32x32x16_bf16 v[56:71], v[28:31], v[52:55], v[56:71]
v_exp_f32 v136, v40
v_exp_f32 v137, v41
v_exp_f32 v138, v42
v_exp_f32 v139, v43
v_mfma_f32_32x32x16_bf16 v[72:87], v[104:107], v[52:55], v[72:87]
v_exp_f32 v140, v44
v_exp_f32 v141, v45
v_exp_f32 v142, v46
v_exp_f32 v143, v47
ds_read_b128 v[24:27], v108 offset:2048
ds_read_b128 v[28:31], v108 offset:3072
s_waitcnt lgkmcnt(2)
v_mfma_f32_32x32x16_bf16 v[32:47], v[16:19], v[8:11], v[88:103]
v_cvt_pk_bf16_f32 v48, v128, v129
v_cvt_pk_bf16_f32 v49, v130, v131
v_cvt_pk_bf16_f32 v50, v132, v133
v_cvt_pk_bf16_f32 v51, v134, v135
v_mfma_f32_32x32x16_bf16 v[32:47], v[20:23], v[12:15], v[32:47]
v_cvt_pk_bf16_f32 v52, v136, v137
v_cvt_pk_bf16_f32 v53, v138, v139
v_cvt_pk_bf16_f32 v54, v140, v141
v_cvt_pk_bf16_f32 v55, v142, v143
v_add_u32 v108, 4096, v108
s_add_u32 s83, s83, 1
s_cmp_lt_u32 s83, s84
s_cbranch_scc1 L_att_remote
s_waitcnt lgkmcnt(0)
v_mfma_f32_32x32x16_bf16 v[56:71], v[24:27], v[48:51], v[56:71]
v_mfma_f32_32x32x16_bf16 v[72:87], v[104:107], v[48:51], v[72:87]
v_mfma_f32_32x32x16_bf16 v[56:71], v[28:31], v[52:55], v[56:71]
v_mfma_f32_32x32x16_bf16 v[72:87], v[104:107], v[52:55], v[72:87]
L_remend_15:
s_nop 7
s_cmp_lg_u32 s82, 0
s_cbranch_scc1 L_att_ok_18
v_mov_b32 v110, 0x5f800000
s_nop 0
v_cmp_nlt_f32 vcc, v72, v110
s_nop 1
s_cbranch_vccz L_att_ok_18
s_cmp_eq_u32 s73, 0
s_cselect_b32 s83, 8, s80
s_cmp_eq_u32 s73, 1
s_cselect_b32 s83, 4, s83
s_add_u32 s84, s80, 8
s_cmp_ge_u32 s83, s84
s_cbranch_scc1 L_tm_done_21
L_tm_loop_19:
s_lshl_b32 s86, s83, 12
v_add_u32 v108, s86, v111
ds_read_b128 v[16:19], v108 offset:0
ds_read_b128 v[20:23], v108 offset:1024
s_waitcnt lgkmcnt(0)
v_mfma_f32_32x32x16_bf16 v[32:47], v[16:19], v[8:11], 0
v_mfma_f32_32x32x16_bf16 v[32:47], v[20:23], v[12:15], v[32:47]
s_cmp_lt_u32 s73, 2
s_cbranch_scc1 L_tm_nomask_20
s_cmp_lg_u32 s83, s80
s_cbranch_scc1 L_tm_nomask_20
s_nop 7
v_cndmask_b32 v32, v32, v112, s[4:5]
v_cndmask_b32 v33, v33, v112, s[6:7]
v_cndmask_b32 v34, v34, v112, s[8:9]
v_cndmask_b32 v35, v35, v112, s[10:11]
v_cndmask_b32 v36, v36, v112, s[12:13]
v_cndmask_b32 v37, v37, v112, s[14:15]
v_cndmask_b32 v38, v38, v112, s[16:17]
v_cndmask_b32 v39, v39, v112, s[18:19]
v_cndmask_b32 v40, v40, v112, s[20:21]
v_cndmask_b32 v41, v41, v112, s[22:23]
v_cndmask_b32 v42, v42, v112, s[24:25]
v_cndmask_b32 v43, v43, v112, s[26:27]
v_cndmask_b32 v44, v44, v112, s[28:29]
v_cndmask_b32 v45, v45, v112, s[30:31]
v_cndmask_b32 v46, v46, v112, s[32:33]
v_cndmask_b32 v47, v47, v112, s[34:35]
L_tm_nomask_20:
s_nop 7
s_nop 3
v_max3_f32 v109, v109, v32, v33
v_max3_f32 v109, v109, v34, v35
v_max3_f32 v109, v109, v36, v37
v_max3_f32 v109, v109, v38, v39
v_max3_f32 v109, v109, v40, v41
v_max3_f32 v109, v109, v42, v43
v_max3_f32 v109, v109, v44, v45
v_max3_f32 v109, v109, v46, v47
s_add_u32 s83, s83, 1
s_cmp_lt_u32 s83, s84
s_cbranch_scc1 L_tm_loop_19
L_tm_done_21:
v_mov_b32 v110, v109
s_nop 1
v_permlane32_swap_b32 v109, v110
v_max_f32 v109, v109, v110
s_mov_b32 s82, 1
s_branch L_att_start
L_att_ok_18:
s_nop 5
v_rcp_f32 v109, v72
s_nop 0
v_pk_mul_f32 v[56:57], v[56:57], v[108:109] op_sel:[0,1] op_sel_hi:[1,1]
v_pk_mul_f32 v[58:59], v[58:59], v[108:109] op_sel:[0,1] op_sel_hi:[1,1]
v_pk_mul_f32 v[60:61], v[60:61], v[108:109] op_sel:[0,1] op_sel_hi:[1,1]
v_pk_mul_f32 v[62:63], v[62:63], v[108:109] op_sel:[0,1] op_sel_hi:[1,1]
v_pk_mul_f32 v[64:65], v[64:65], v[108:109] op_sel:[0,1] op_sel_hi:[1,1]
v_pk_mul_f32 v[66:67], v[66:67], v[108:109] op_sel:[0,1] op_sel_hi:[1,1]
v_pk_mul_f32 v[68:69], v[68:69], v[108:109] op_sel:[0,1] op_sel_hi:[1,1]
v_pk_mul_f32 v[70:71], v[70:71], v[108:109] op_sel:[0,1] op_sel_hi:[1,1]
v_cvt_pk_bf16_f32 v48, v56, v57
v_cvt_pk_bf16_f32 v49, v58, v59
v_cvt_pk_bf16_f32 v50, v60, v61
v_cvt_pk_bf16_f32 v51, v62, v63
v_cvt_pk_bf16_f32 v52, v64, v65
v_cvt_pk_bf16_f32 v53, v66, v67
v_cvt_pk_bf16_f32 v54, v68, v69
v_cvt_pk_bf16_f32 v55, v70, v71
buffer_store_dwordx4 v[48:51], v116, s[44:47], 0 offen sc1
buffer_store_dwordx4 v[52:55], v116, s[44:47], 0 offen offset:512 sc1
v_mov_b32 v5, s77
v_cmp_eq_u32 vcc, 0, v1
s_waitcnt vmcnt(0)
s_nop 0
s_and_saveexec_b64 s[96:97], vcc
buffer_store_dword v5, v117, s[44:47], 0 offen sc1
s_mov_b64 exec, s[96:97]
s_and_b32 s80, s72, 3
s_lshr_b32 s81, s72, 2
s_barrier
v_lshrrev_b32 v2, 3, v1
v_and_b32 v4, 7, v1
v_bfe_u32 v5, v2, 1, 2
v_lshlrev_b32 v5, 1, v5
v_xor_b32 v5, v5, v4
s_mul_i32 s86, s72, 8
s_add_u32 s86, s86, 64
s_lshl_b32 s87, s86, 3
v_add_u32 v6, s87, v2
v_lshlrev_b32 v6, 11, v6
s_lshl_b32 s87, s76, 7
v_lshl_add_u32 v6, v5, 4, v6
v_add_u32 v6, s87, v6
s_lshl_b32 s86, s86, 10
s_sub_u32 m0, s86, 65536
s_mov_b32 s87, 0
buffer_load_dwordx4 v6, s[40:43], s87 offen lds
s_add_u32 m0, m0, 0x400
s_mov_b32 s87, 16384
buffer_load_dwordx4 v6, s[40:43], s87 offen lds
s_add_u32 m0, m0, 0x400
s_mov_b32 s87, 32768
buffer_load_dwordx4 v6, s[40:43], s87 offen lds
s_add_u32 m0, m0, 0x400
s_mov_b32 s87, 49152
buffer_load_dwordx4 v6, s[40:43], s87 offen lds
s_add_u32 m0, m0, 0x400
s_mov_b32 s87, 65536
buffer_load_dwordx4 v6, s[40:43], s87 offen lds
s_add_u32 m0, m0, 0x400
s_mov_b32 s87, 81920
buffer_load_dwordx4 v6, s[40:43], s87 offen lds
s_add_u32 m0, m0, 0x400
s_mov_b32 s87, 98304
buffer_load_dwordx4 v6, s[40:43], s87 offen lds
s_add_u32 m0, m0, 0x400
s_mov_b32 s87, 114688
buffer_load_dwordx4 v6, s[40:43], s87 offen lds
v_lshrrev_b32 v2, 4, v1
v_and_b32 v4, 15, v1
v_lshrrev_b32 v6, 1, v2
v_lshlrev_b32 v6, 4, v6
v_and_b32 v7, 1, v2
v_lshl_add_u32 v6, v7, 2, v6
v_lshrrev_b32 v8, 2, v4
v_add_u32 v6, v6, v8
v_lshlrev_b32 v6, 7, v6
v_and_b32 v8, 3, v4
v_lshl_add_u32 v6, v8, 3, v6
s_cmp_eq_u32 s81, 0
s_cselect_b32 s87, 98304, 0
v_add_u32 v6, s87, v6
v_bfe_u32 v8, v4, 3, 1
v_lshl_add_u32 v8, v7, 1, v8
s_lshl_b32 s87, s81, 1
v_xor_b32 v8, s87, v8
v_xor_b32 v9, 0, v8
v_lshl_add_u32 v72, v9, 5, v6
v_xor_b32 v9, 1, v8
v_lshl_add_u32 v73, v9, 5, v6
v_xor_b32 v9, 2, v8
v_lshl_add_u32 v74, v9, 5, v6
v_xor_b32 v9, 3, v8
v_lshl_add_u32 v75, v9, 5, v6
s_lshl_b32 s86, s76, 7
s_lshl_b32 s87, s81, 6
s_add_u32 s86, s86, s87
v_lshl_add_u32 v97, v2, 3, s86
s_lshl_b32 s87, s75, 7
s_lshl_b32 s88, s80, 5
s_add_u32 s87, s87, s88
v_add_u32 v6, s87, v4
v_lshl_add_u32 v98, v6, 11, v97
v_lshlrev_b32 v99, 4, v1
s_lshl_b32 s86, s75, 3
s_lshl_b32 s87, s80, 1
s_add_u32 s86, s86, s87
s_lshl_b32 s86, s86, 5
s_lshl_b32 s87, s81, 4
s_add_u32 s86, s86, s87
s_lshl_b32 s86, s86, 10
s_add_u32 s86, s86, 8388608
v_add_u32 v108, s86, v99
v_add_u32 v109, 32768, v108
s_lshl_b32 s86, s75, 2
s_add_u32 s86, s86, s80
s_lshl_b32 s86, s86, 7
s_lshl_b32 s87, s81, 6
s_add_u32 s86, s86, s87
s_add_u32 s86, s86, 13041664
s_mov_b32 s90, 0
L_opoll_22:
s_load_dwordx16 s[4:19], s[44:45], s86 glc
s_waitcnt lgkmcnt(0)
s_xor_b32 s4, s4, s77
s_xor_b32 s5, s5, s77
s_or_b32 s4, s4, s5
s_xor_b32 s6, s6, s77
s_or_b32 s4, s4, s6
s_xor_b32 s7, s7, s77
s_or_b32 s4, s4, s7
s_xor_b32 s8, s8, s77
s_or_b32 s4, s4, s8
s_xor_b32 s9, s9, s77
s_or_b32 s4, s4, s9
s_xor_b32 s10, s10, s77
s_or_b32 s4, s4, s10
s_xor_b32 s11, s11, s77
s_or_b32 s4, s4, s11
s_xor_b32 s12, s12, s77
s_or_b32 s4, s4, s12
s_xor_b32 s13, s13, s77
s_or_b32 s4, s4, s13
s_xor_b32 s14, s14, s77
s_or_b32 s4, s4, s14
s_xor_b32 s15, s15, s77
s_or_b32 s4, s4, s15
s_xor_b32 s16, s16, s77
s_or_b32 s4, s4, s16
s_xor_b32 s17, s17, s77
s_or_b32 s4, s4, s17
s_xor_b32 s18, s18, s77
s_or_b32 s4, s4, s18
s_xor_b32 s19, s19, s77
s_or_b32 s4, s4, s19
s_cmp_eq_u32 s4, 0
s_cbranch_scc1 L_ook_23
s_add_u32 s90, s90, 1
s_cmp_gt_u32 s90, 200000
s_cbranch_scc1 L_ook_23
s_branch L_opoll_22
L_ook_23:
s_mov_b32 s87, 0
buffer_load_dwordx4 v[112:115], v108, s[44:47], s87 offen offset:0 sc1
buffer_load_dwordx4 v[116:119], v109, s[44:47], s87 offen offset:0 sc1
s_mov_b32 s87, 0
buffer_load_dwordx4 v[120:123], v108, s[44:47], s87 offen offset:1024 sc1
buffer_load_dwordx4 v[124:127], v109, s[44:47], s87 offen offset:1024 sc1
buffer_load_dwordx2 v[84:85], v97, s[64:67], 0 offen offset:0
buffer_load_dwordx2 v[86:87], v97, s[64:67], 0 offen offset:32
buffer_load_dwordx4 v[100:103], v99, s[64:67], 0 offen
buffer_load_dwordx4 v[104:107], v99, s[64:67], 0 offen offset:1024
s_mov_b32 s87, 0
buffer_load_dwordx4 v[128:131], v108, s[44:47], s87 offen offset:2048 sc1
buffer_load_dwordx4 v[132:135], v109, s[44:47], s87 offen offset:2048 sc1
s_mov_b32 s87, 0
buffer_load_dwordx4 v[136:139], v108, s[44:47], s87 offen offset:3072 sc1
buffer_load_dwordx4 v[140:143], v109, s[44:47], s87 offen offset:3072 sc1
s_waitcnt vmcnt(12)
s_barrier
ds_read_b64_tr_b16 v[40:41], v72 offset:0
ds_read_b64_tr_b16 v[42:43], v72 offset:1024
ds_read_b64_tr_b16 v[44:45], v73 offset:0
ds_read_b64_tr_b16 v[46:47], v73 offset:1024
ds_read_b64_tr_b16 v[48:49], v74 offset:0
ds_read_b64_tr_b16 v[50:51], v74 offset:1024
ds_read_b64_tr_b16 v[52:53], v75 offset:0
ds_read_b64_tr_b16 v[54:55], v75 offset:1024
s_mov_b32 s87, 4096
buffer_load_dwordx4 v[144:147], v108, s[44:47], s87 offen offset:0 sc1
buffer_load_dwordx4 v[148:151], v109, s[44:47], s87 offen offset:0 sc1
s_waitcnt vmcnt(12) lgkmcnt(0)
v_mfma_f32_16x16x32_bf16 v[8:11], v[40:43], v[112:115], 0
ds_read_b64_tr_b16 v[56:57], v72 offset:4096
v_mfma_f32_16x16x32_bf16 v[12:15], v[40:43], v[116:119], 0
ds_read_b64_tr_b16 v[58:59], v72 offset:5120
v_mfma_f32_16x16x32_bf16 v[16:19], v[44:47], v[112:115], 0
ds_read_b64_tr_b16 v[60:61], v73 offset:4096
v_mfma_f32_16x16x32_bf16 v[20:23], v[44:47], v[116:119], 0
ds_read_b64_tr_b16 v[62:63], v73 offset:5120
v_mfma_f32_16x16x32_bf16 v[24:27], v[48:51], v[112:115], 0
ds_read_b64_tr_b16 v[64:65], v74 offset:4096
v_mfma_f32_16x16x32_bf16 v[28:31], v[48:51], v[116:119], 0
ds_read_b64_tr_b16 v[66:67], v74 offset:5120
v_mfma_f32_16x16x32_bf16 v[32:35], v[52:55], v[112:115], 0
ds_read_b64_tr_b16 v[68:69], v75 offset:4096
v_mfma_f32_16x16x32_bf16 v[36:39], v[52:55], v[116:119], 0
ds_read_b64_tr_b16 v[70:71], v75 offset:5120
s_mov_b32 s87, 4096
buffer_load_dwordx4 v[112:115], v108, s[44:47], s87 offen offset:1024 sc1
buffer_load_dwordx4 v[116:119], v109, s[44:47], s87 offen offset:1024 sc1
s_waitcnt vmcnt(12) lgkmcnt(0)
v_mfma_f32_16x16x32_bf16 v[8:11], v[56:59], v[120:123], v[8:11]
ds_read_b64_tr_b16 v[40:41], v72 offset:8192
v_mfma_f32_16x16x32_bf16 v[12:15], v[56:59], v[124:127], v[12:15]
ds_read_b64_tr_b16 v[42:43], v72 offset:9216
v_mfma_f32_16x16x32_bf16 v[16:19], v[60:63], v[120:123], v[16:19]
ds_read_b64_tr_b16 v[44:45], v73 offset:8192
v_mfma_f32_16x16x32_bf16 v[20:23], v[60:63], v[124:127], v[20:23]
ds_read_b64_tr_b16 v[46:47], v73 offset:9216
v_mfma_f32_16x16x32_bf16 v[24:27], v[64:67], v[120:123], v[24:27]
ds_read_b64_tr_b16 v[48:49], v74 offset:8192
v_mfma_f32_16x16x32_bf16 v[28:31], v[64:67], v[124:127], v[28:31]
ds_read_b64_tr_b16 v[50:51], v74 offset:9216
v_mfma_f32_16x16x32_bf16 v[32:35], v[68:71], v[120:123], v[32:35]
ds_read_b64_tr_b16 v[52:53], v75 offset:8192
v_mfma_f32_16x16x32_bf16 v[36:39], v[68:71], v[124:127], v[36:39]
ds_read_b64_tr_b16 v[54:55], v75 offset:9216
s_mov_b32 s87, 4096
buffer_load_dwordx4 v[120:123], v108, s[44:47], s87 offen offset:2048 sc1
buffer_load_dwordx4 v[124:127], v109, s[44:47], s87 offen offset:2048 sc1
s_waitcnt vmcnt(8) lgkmcnt(0)
v_mfma_f32_16x16x32_bf16 v[8:11], v[40:43], v[128:131], v[8:11]
ds_read_b64_tr_b16 v[56:57], v72 offset:12288
v_mfma_f32_16x16x32_bf16 v[12:15], v[40:43], v[132:135], v[12:15]
ds_read_b64_tr_b16 v[58:59], v72 offset:13312
v_mfma_f32_16x16x32_bf16 v[16:19], v[44:47], v[128:131], v[16:19]
ds_read_b64_tr_b16 v[60:61], v73 offset:12288
v_mfma_f32_16x16x32_bf16 v[20:23], v[44:47], v[132:135], v[20:23]
ds_read_b64_tr_b16 v[62:63], v73 offset:13312
v_mfma_f32_16x16x32_bf16 v[24:27], v[48:51], v[128:131], v[24:27]
ds_read_b64_tr_b16 v[64:65], v74 offset:12288
v_mfma_f32_16x16x32_bf16 v[28:31], v[48:51], v[132:135], v[28:31]
ds_read_b64_tr_b16 v[66:67], v74 offset:13312
v_mfma_f32_16x16x32_bf16 v[32:35], v[52:55], v[128:131], v[32:35]
ds_read_b64_tr_b16 v[68:69], v75 offset:12288
v_mfma_f32_16x16x32_bf16 v[36:39], v[52:55], v[132:135], v[36:39]
ds_read_b64_tr_b16 v[70:71], v75 offset:13312
s_mov_b32 s87, 4096
buffer_load_dwordx4 v[128:131], v108, s[44:47], s87 offen offset:3072 sc1
buffer_load_dwordx4 v[132:135], v109, s[44:47], s87 offen offset:3072 sc1
s_waitcnt vmcnt(8) lgkmcnt(0)
v_mfma_f32_16x16x32_bf16 v[8:11], v[56:59], v[136:139], v[8:11]
ds_read_b64_tr_b16 v[40:41], v72 offset:16384
v_lshlrev_b32 v110, 16, v100
v_mfma_f32_16x16x32_bf16 v[12:15], v[56:59], v[140:143], v[12:15]
ds_read_b64_tr_b16 v[42:43], v72 offset:17408
v_and_b32 v111, 0xffff0000, v100
v_mfma_f32_16x16x32_bf16 v[16:19], v[60:63], v[136:139], v[16:19]
ds_read_b64_tr_b16 v[44:45], v73 offset:16384
v_add_f32 v96, v110, v111
v_mfma_f32_16x16x32_bf16 v[20:23], v[60:63], v[140:143], v[20:23]
ds_read_b64_tr_b16 v[46:47], v73 offset:17408
v_lshlrev_b32 v110, 16, v101
v_mfma_f32_16x16x32_bf16 v[24:27], v[64:67], v[136:139], v[24:27]
ds_read_b64_tr_b16 v[48:49], v74 offset:16384
v_and_b32 v111, 0xffff0000, v101
v_mfma_f32_16x16x32_bf16 v[28:31], v[64:67], v[140:143], v[28:31]
ds_read_b64_tr_b16 v[50:51], v74 offset:17408
v_add_f32 v110, v110, v111
v_mfma_f32_16x16x32_bf16 v[32:35], v[68:71], v[136:139], v[32:35]
ds_read_b64_tr_b16 v[52:53], v75 offset:16384
v_add_f32 v96, v96, v110
v_mfma_f32_16x16x32_bf16 v[36:39], v[68:71], v[140:143], v[36:39]
ds_read_b64_tr_b16 v[54:55], v75 offset:17408
v_lshlrev_b32 v110, 16, v102
s_mov_b32 s87, 8192
buffer_load_dwordx4 v[136:139], v108, s[44:47], s87 offen offset:0 sc1
buffer_load_dwordx4 v[140:143], v109, s[44:47], s87 offen offset:0 sc1
s_waitcnt vmcnt(8) lgkmcnt(0)
v_mfma_f32_16x16x32_bf16 v[8:11], v[40:43], v[144:147], v[8:11]
ds_read_b64_tr_b16 v[56:57], v72 offset:20480
v_and_b32 v111, 0xffff0000, v102
v_mfma_f32_16x16x32_bf16 v[12:15], v[40:43], v[148:151], v[12:15]
ds_read_b64_tr_b16 v[58:59], v72 offset:21504
v_add_f32 v110, v110, v111
v_mfma_f32_16x16x32_bf16 v[16:19], v[44:47], v[144:147], v[16:19]
ds_read_b64_tr_b16 v[60:61], v73 offset:20480
v_add_f32 v96, v96, v110
v_mfma_f32_16x16x32_bf16 v[20:23], v[44:47], v[148:151], v[20:23]
ds_read_b64_tr_b16 v[62:63], v73 offset:21504
v_lshlrev_b32 v110, 16, v103
v_mfma_f32_16x16x32_bf16 v[24:27], v[48:51], v[144:147], v[24:27]
ds_read_b64_tr_b16 v[64:65], v74 offset:20480
v_and_b32 v111, 0xffff0000, v103
v_mfma_f32_16x16x32_bf16 v[28:31], v[48:51], v[148:151], v[28:31]
ds_read_b64_tr_b16 v[66:67], v74 offset:21504
v_add_f32 v110, v110, v111
v_mfma_f32_16x16x32_bf16 v[32:35], v[52:55], v[144:147], v[32:35]
ds_read_b64_tr_b16 v[68:69], v75 offset:20480
v_add_f32 v96, v96, v110
v_mfma_f32_16x16x32_bf16 v[36:39], v[52:55], v[148:151], v[36:39]
ds_read_b64_tr_b16 v[70:71], v75 offset:21504
v_lshlrev_b32 v110, 16, v104
s_mov_b32 s87, 8192
buffer_load_dwordx4 v[144:147], v108, s[44:47], s87 offen offset:1024 sc1
buffer_load_dwordx4 v[148:151], v109, s[44:47], s87 offen offset:1024 sc1
s_waitcnt vmcnt(8) lgkmcnt(0)
v_mfma_f32_16x16x32_bf16 v[8:11], v[56:59], v[112:115], v[8:11]
ds_read_b64_tr_b16 v[40:41], v72 offset:24576
v_and_b32 v111, 0xffff0000, v104
v_mfma_f32_16x16x32_bf16 v[12:15], v[56:59], v[116:119], v[12:15]
ds_read_b64_tr_b16 v[42:43], v72 offset:25600
v_add_f32 v110, v110, v111
v_mfma_f32_16x16x32_bf16 v[16:19], v[60:63], v[112:115], v[16:19]
ds_read_b64_tr_b16 v[44:45], v73 offset:24576
v_add_f32 v96, v96, v110
v_mfma_f32_16x16x32_bf16 v[20:23], v[60:63], v[116:119], v[20:23]
ds_read_b64_tr_b16 v[46:47], v73 offset:25600
v_lshlrev_b32 v110, 16, v105
v_mfma_f32_16x16x32_bf16 v[24:27], v[64:67], v[112:115], v[24:27]
ds_read_b64_tr_b16 v[48:49], v74 offset:24576
v_and_b32 v111, 0xffff0000, v105
v_mfma_f32_16x16x32_bf16 v[28:31], v[64:67], v[116:119], v[28:31]
ds_read_b64_tr_b16 v[50:51], v74 offset:25600
v_add_f32 v110, v110, v111
v_mfma_f32_16x16x32_bf16 v[32:35], v[68:71], v[112:115], v[32:35]
ds_read_b64_tr_b16 v[52:53], v75 offset:24576
v_add_f32 v96, v96, v110
v_mfma_f32_16x16x32_bf16 v[36:39], v[68:71], v[116:119], v[36:39]
ds_read_b64_tr_b16 v[54:55], v75 offset:25600
v_lshlrev_b32 v110, 16, v106
s_mov_b32 s87, 8192
buffer_load_dwordx4 v[112:115], v108, s[44:47], s87 offen offset:2048 sc1
buffer_load_dwordx4 v[116:119], v109, s[44:47], s87 offen offset:2048 sc1
s_waitcnt vmcnt(8) lgkmcnt(0)
v_mfma_f32_16x16x32_bf16 v[8:11], v[40:43], v[120:123], v[8:11]
ds_read_b64_tr_b16 v[56:57], v72 offset:28672
v_and_b32 v111, 0xffff0000, v106
v_mfma_f32_16x16x32_bf16 v[12:15], v[40:43], v[124:127], v[12:15]
ds_read_b64_tr_b16 v[58:59], v72 offset:29696
v_add_f32 v110, v110, v111
v_mfma_f32_16x16x32_bf16 v[16:19], v[44:47], v[120:123], v[16:19]
ds_read_b64_tr_b16 v[60:61], v73 offset:28672
v_add_f32 v96, v96, v110
v_mfma_f32_16x16x32_bf16 v[20:23], v[44:47], v[124:127], v[20:23]
ds_read_b64_tr_b16 v[62:63], v73 offset:29696
v_lshlrev_b32 v110, 16, v107
v_mfma_f32_16x16x32_bf16 v[24:27], v[48:51], v[120:123], v[24:27]
ds_read_b64_tr_b16 v[64:65], v74 offset:28672
v_and_b32 v111, 0xffff0000, v107
v_mfma_f32_16x16x32_bf16 v[28:31], v[48:51], v[124:127], v[28:31]
ds_read_b64_tr_b16 v[66:67], v74 offset:29696
v_add_f32 v110, v110, v111
v_mfma_f32_16x16x32_bf16 v[32:35], v[52:55], v[120:123], v[32:35]
ds_read_b64_tr_b16 v[68:69], v75 offset:28672
v_add_f32 v96, v96, v110
v_mfma_f32_16x16x32_bf16 v[36:39], v[52:55], v[124:127], v[36:39]
ds_read_b64_tr_b16 v[70:71], v75 offset:29696
v_add_f32_dpp v96, v96, v96 quad_perm:[1,0,3,2] row_mask:0xf bank_mask:0xf
s_mov_b32 s87, 8192
buffer_load_dwordx4 v[120:123], v108, s[44:47], s87 offen offset:3072 sc1
buffer_load_dwordx4 v[124:127], v109, s[44:47], s87 offen offset:3072 sc1
s_waitcnt vmcnt(8) lgkmcnt(0)
v_mfma_f32_16x16x32_bf16 v[8:11], v[56:59], v[128:131], v[8:11]
ds_read_b64_tr_b16 v[40:41], v72 offset:32768
v_add_f32_dpp v96, v96, v96 quad_perm:[2,3,0,1] row_mask:0xf bank_mask:0xf
v_mfma_f32_16x16x32_bf16 v[12:15], v[56:59], v[132:135], v[12:15]
ds_read_b64_tr_b16 v[42:43], v72 offset:33792
v_add_f32_dpp v96, v96, v96 row_half_mirror row_mask:0xf bank_mask:0xf
v_mfma_f32_16x16x32_bf16 v[16:19], v[60:63], v[128:131], v[16:19]
ds_read_b64_tr_b16 v[44:45], v73 offset:32768
v_add_f32_dpp v96, v96, v96 row_mirror row_mask:0xf bank_mask:0xf
v_mfma_f32_16x16x32_bf16 v[20:23], v[60:63], v[132:135], v[20:23]
ds_read_b64_tr_b16 v[46:47], v73 offset:33792
v_mov_b32 v110, v96
v_mfma_f32_16x16x32_bf16 v[24:27], v[64:67], v[128:131], v[24:27]
ds_read_b64_tr_b16 v[48:49], v74 offset:32768
v_permlane16_swap_b32 v96, v110
v_mfma_f32_16x16x32_bf16 v[28:31], v[64:67], v[132:135], v[28:31]
ds_read_b64_tr_b16 v[50:51], v74 offset:33792
v_add_f32 v96, v96, v110
v_mfma_f32_16x16x32_bf16 v[32:35], v[68:71], v[128:131], v[32:35]
ds_read_b64_tr_b16 v[52:53], v75 offset:32768
v_mov_b32 v110, v96
v_mfma_f32_16x16x32_bf16 v[36:39], v[68:71], v[132:135], v[36:39]
ds_read_b64_tr_b16 v[54:55], v75 offset:33792
v_permlane32_swap_b32 v96, v110
s_mov_b32 s87, 12288
buffer_load_dwordx4 v[128:131], v108, s[44:47], s87 offen offset:0 sc1
buffer_load_dwordx4 v[132:135], v109, s[44:47], s87 offen offset:0 sc1
s_waitcnt vmcnt(8) lgkmcnt(0)
v_mfma_f32_16x16x32_bf16 v[8:11], v[40:43], v[136:139], v[8:11]
ds_read_b64_tr_b16 v[56:57], v72 offset:36864
v_add_f32 v96, v96, v110
v_mfma_f32_16x16x32_bf16 v[12:15], v[40:43], v[140:143], v[12:15]
ds_read_b64_tr_b16 v[58:59], v72 offset:37888
v_lshlrev_b32 v88, 16, v84
v_mfma_f32_16x16x32_bf16 v[16:19], v[44:47], v[136:139], v[16:19]
ds_read_b64_tr_b16 v[60:61], v73 offset:36864
v_and_b32 v89, 0xffff0000, v84
v_mfma_f32_16x16x32_bf16 v[20:23], v[44:47], v[140:143], v[20:23]
ds_read_b64_tr_b16 v[62:63], v73 offset:37888
v_lshlrev_b32 v90, 16, v85
v_mfma_f32_16x16x32_bf16 v[24:27], v[48:51], v[136:139], v[24:27]
ds_read_b64_tr_b16 v[64:65], v74 offset:36864
v_and_b32 v91, 0xffff0000, v85
v_mfma_f32_16x16x32_bf16 v[28:31], v[48:51], v[140:143], v[28:31]
ds_read_b64_tr_b16 v[66:67], v74 offset:37888
v_lshlrev_b32 v92, 16, v86
v_mfma_f32_16x16x32_bf16 v[32:35], v[52:55], v[136:139], v[32:35]
ds_read_b64_tr_b16 v[68:69], v75 offset:36864
v_and_b32 v93, 0xffff0000, v86
v_mfma_f32_16x16x32_bf16 v[36:39], v[52:55], v[140:143], v[36:39]
ds_read_b64_tr_b16 v[70:71], v75 offset:37888
v_lshlrev_b32 v94, 16, v87
s_mov_b32 s87, 12288
buffer_load_dwordx4 v[136:139], v108, s[44:47], s87 offen offset:1024 sc1
buffer_load_dwordx4 v[140:143], v109, s[44:47], s87 offen offset:1024 sc1
s_waitcnt vmcnt(8) lgkmcnt(0)
v_mfma_f32_16x16x32_bf16 v[8:11], v[56:59], v[144:147], v[8:11]
ds_read_b64_tr_b16 v[40:41], v72 offset:40960
v_and_b32 v95, 0xffff0000, v87
v_mfma_f32_16x16x32_bf16 v[12:15], v[56:59], v[148:151], v[12:15]
ds_read_b64_tr_b16 v[42:43], v72 offset:41984
v_mfma_f32_16x16x32_bf16 v[16:19], v[60:63], v[144:147], v[16:19]
ds_read_b64_tr_b16 v[44:45], v73 offset:40960
v_mfma_f32_16x16x32_bf16 v[20:23], v[60:63], v[148:151], v[20:23]
ds_read_b64_tr_b16 v[46:47], v73 offset:41984
v_mfma_f32_16x16x32_bf16 v[24:27], v[64:67], v[144:147], v[24:27]
ds_read_b64_tr_b16 v[48:49], v74 offset:40960
v_mfma_f32_16x16x32_bf16 v[28:31], v[64:67], v[148:151], v[28:31]
ds_read_b64_tr_b16 v[50:51], v74 offset:41984
v_mfma_f32_16x16x32_bf16 v[32:35], v[68:71], v[144:147], v[32:35]
ds_read_b64_tr_b16 v[52:53], v75 offset:40960
v_mfma_f32_16x16x32_bf16 v[36:39], v[68:71], v[148:151], v[36:39]
ds_read_b64_tr_b16 v[54:55], v75 offset:41984
s_mov_b32 s87, 12288
buffer_load_dwordx4 v[144:147], v108, s[44:47], s87 offen offset:2048 sc1
buffer_load_dwordx4 v[148:151], v109, s[44:47], s87 offen offset:2048 sc1
s_waitcnt vmcnt(8) lgkmcnt(0)
v_mfma_f32_16x16x32_bf16 v[8:11], v[40:43], v[112:115], v[8:11]
ds_read_b64_tr_b16 v[56:57], v72 offset:45056
v_mfma_f32_16x16x32_bf16 v[12:15], v[40:43], v[116:119], v[12:15]
ds_read_b64_tr_b16 v[58:59], v72 offset:46080
v_mfma_f32_16x16x32_bf16 v[16:19], v[44:47], v[112:115], v[16:19]
ds_read_b64_tr_b16 v[60:61], v73 offset:45056
v_mfma_f32_16x16x32_bf16 v[20:23], v[44:47], v[116:119], v[20:23]
ds_read_b64_tr_b16 v[62:63], v73 offset:46080
v_mfma_f32_16x16x32_bf16 v[24:27], v[48:51], v[112:115], v[24:27]
ds_read_b64_tr_b16 v[64:65], v74 offset:45056
v_mfma_f32_16x16x32_bf16 v[28:31], v[48:51], v[116:119], v[28:31]
ds_read_b64_tr_b16 v[66:67], v74 offset:46080
v_mfma_f32_16x16x32_bf16 v[32:35], v[52:55], v[112:115], v[32:35]
ds_read_b64_tr_b16 v[68:69], v75 offset:45056
v_mfma_f32_16x16x32_bf16 v[36:39], v[52:55], v[116:119], v[36:39]
ds_read_b64_tr_b16 v[70:71], v75 offset:46080
s_mov_b32 s87, 12288
buffer_load_dwordx4 v[112:115], v108, s[44:47], s87 offen offset:3072 sc1
buffer_load_dwordx4 v[116:119], v109, s[44:47], s87 offen offset:3072 sc1
s_waitcnt vmcnt(8) lgkmcnt(0)
v_mfma_f32_16x16x32_bf16 v[8:11], v[56:59], v[120:123], v[8:11]
ds_read_b64_tr_b16 v[40:41], v72 offset:49152
v_mfma_f32_16x16x32_bf16 v[12:15], v[56:59], v[124:127], v[12:15]
ds_read_b64_tr_b16 v[42:43], v72 offset:50176
v_mfma_f32_16x16x32_bf16 v[16:19], v[60:63], v[120:123], v[16:19]
ds_read_b64_tr_b16 v[44:45], v73 offset:49152
v_mfma_f32_16x16x32_bf16 v[20:23], v[60:63], v[124:127], v[20:23]
ds_read_b64_tr_b16 v[46:47], v73 offset:50176
v_mfma_f32_16x16x32_bf16 v[24:27], v[64:67], v[120:123], v[24:27]
ds_read_b64_tr_b16 v[48:49], v74 offset:49152
v_mfma_f32_16x16x32_bf16 v[28:31], v[64:67], v[124:127], v[28:31]
ds_read_b64_tr_b16 v[50:51], v74 offset:50176
v_mfma_f32_16x16x32_bf16 v[32:35], v[68:71], v[120:123], v[32:35]
ds_read_b64_tr_b16 v[52:53], v75 offset:49152
v_mfma_f32_16x16x32_bf16 v[36:39], v[68:71], v[124:127], v[36:39]
ds_read_b64_tr_b16 v[54:55], v75 offset:50176
s_mov_b32 s87, 32768
buffer_load_dwordx2 v[76:77], v98, s[36:39], 0 offen offset:0
buffer_load_dwordx2 v[78:79], v98, s[36:39], 0 offen offset:32
buffer_load_dwordx2 v[80:81], v98, s[36:39], s87 offen offset:0
buffer_load_dwordx2 v[82:83], v98, s[36:39], s87 offen offset:32
s_waitcnt vmcnt(10) lgkmcnt(0)
v_mfma_f32_16x16x32_bf16 v[8:11], v[40:43], v[128:131], v[8:11]
ds_read_b64_tr_b16 v[56:57], v72 offset:53248
v_mfma_f32_16x16x32_bf16 v[12:15], v[40:43], v[132:135], v[12:15]
ds_read_b64_tr_b16 v[58:59], v72 offset:54272
v_mfma_f32_16x16x32_bf16 v[16:19], v[44:47], v[128:131], v[16:19]
ds_read_b64_tr_b16 v[60:61], v73 offset:53248
v_mfma_f32_16x16x32_bf16 v[20:23], v[44:47], v[132:135], v[20:23]
ds_read_b64_tr_b16 v[62:63], v73 offset:54272
v_mfma_f32_16x16x32_bf16 v[24:27], v[48:51], v[128:131], v[24:27]
ds_read_b64_tr_b16 v[64:65], v74 offset:53248
v_mfma_f32_16x16x32_bf16 v[28:31], v[48:51], v[132:135], v[28:31]
ds_read_b64_tr_b16 v[66:67], v74 offset:54272
v_mfma_f32_16x16x32_bf16 v[32:35], v[52:55], v[128:131], v[32:35]
ds_read_b64_tr_b16 v[68:69], v75 offset:53248
v_mfma_f32_16x16x32_bf16 v[36:39], v[52:55], v[132:135], v[36:39]
ds_read_b64_tr_b16 v[70:71], v75 offset:54272
s_waitcnt vmcnt(8) lgkmcnt(0)
v_mfma_f32_16x16x32_bf16 v[8:11], v[56:59], v[136:139], v[8:11]
ds_read_b64_tr_b16 v[40:41], v72 offset:57344
v_mfma_f32_16x16x32_bf16 v[12:15], v[56:59], v[140:143], v[12:15]
ds_read_b64_tr_b16 v[42:43], v72 offset:58368
v_mfma_f32_16x16x32_bf16 v[16:19], v[60:63], v[136:139], v[16:19]
ds_read_b64_tr_b16 v[44:45], v73 offset:57344
v_mfma_f32_16x16x32_bf16 v[20:23], v[60:63], v[140:143], v[20:23]
ds_read_b64_tr_b16 v[46:47], v73 offset:58368
v_mfma_f32_16x16x32_bf16 v[24:27], v[64:67], v[136:139], v[24:27]
ds_read_b64_tr_b16 v[48:49], v74 offset:57344
v_mfma_f32_16x16x32_bf16 v[28:31], v[64:67], v[140:143], v[28:31]
ds_read_b64_tr_b16 v[50:51], v74 offset:58368
v_mfma_f32_16x16x32_bf16 v[32:35], v[68:71], v[136:139], v[32:35]
ds_read_b64_tr_b16 v[52:53], v75 offset:57344
v_mfma_f32_16x16x32_bf16 v[36:39], v[68:71], v[140:143], v[36:39]
ds_read_b64_tr_b16 v[54:55], v75 offset:58368
s_waitcnt vmcnt(6) lgkmcnt(0)
v_mfma_f32_16x16x32_bf16 v[8:11], v[40:43], v[144:147], v[8:11]
ds_read_b64_tr_b16 v[56:57], v72 offset:61440
v_mfma_f32_16x16x32_bf16 v[12:15], v[40:43], v[148:151], v[12:15]
ds_read_b64_tr_b16 v[58:59], v72 offset:62464
v_mfma_f32_16x16x32_bf16 v[16:19], v[44:47], v[144:147], v[16:19]
ds_read_b64_tr_b16 v[60:61], v73 offset:61440
v_mfma_f32_16x16x32_bf16 v[20:23], v[44:47], v[148:151], v[20:23]
ds_read_b64_tr_b16 v[62:63], v73 offset:62464
v_mfma_f32_16x16x32_bf16 v[24:27], v[48:51], v[144:147], v[24:27]
ds_read_b64_tr_b16 v[64:65], v74 offset:61440
v_mfma_f32_16x16x32_bf16 v[28:31], v[48:51], v[148:151], v[28:31]
ds_read_b64_tr_b16 v[66:67], v74 offset:62464
v_mfma_f32_16x16x32_bf16 v[32:35], v[52:55], v[144:147], v[32:35]
ds_read_b64_tr_b16 v[68:69], v75 offset:61440
v_mfma_f32_16x16x32_bf16 v[36:39], v[52:55], v[148:151], v[36:39]
ds_read_b64_tr_b16 v[70:71], v75 offset:62464
s_waitcnt vmcnt(4) lgkmcnt(0)
v_mfma_f32_16x16x32_bf16 v[8:11], v[56:59], v[112:115], v[8:11]
v_mfma_f32_16x16x32_bf16 v[12:15], v[56:59], v[116:119], v[12:15]
v_mfma_f32_16x16x32_bf16 v[16:19], v[60:63], v[112:115], v[16:19]
v_mfma_f32_16x16x32_bf16 v[20:23], v[60:63], v[116:119], v[20:23]
v_mfma_f32_16x16x32_bf16 v[24:27], v[64:67], v[112:115], v[24:27]
v_mfma_f32_16x16x32_bf16 v[28:31], v[64:67], v[116:119], v[28:31]
v_mfma_f32_16x16x32_bf16 v[32:35], v[68:71], v[112:115], v[32:35]
v_mfma_f32_16x16x32_bf16 v[36:39], v[68:71], v[116:119], v[36:39]
s_lshl_b32 s86, s80, 13
s_lshl_b32 s87, s81, 12
s_add_u32 s88, s86, s87
s_add_u32 s88, s88, 65536
s_xor_b32 s87, s87, 4096
s_add_u32 s86, s86, s87
s_add_u32 s86, s86, 65536
v_lshl_add_u32 v6, v1, 4, s86
v_lshl_add_u32 v7, v1, 4, s88
ds_write_b128 v6, v[24:27] offset:0
ds_write_b128 v6, v[28:31] offset:1024
ds_write_b128 v6, v[32:35] offset:2048
ds_write_b128 v6, v[36:39] offset:3072
s_waitcnt vmcnt(0)
v_lshlrev_b32 v48, 16, v76
v_and_b32 v49, 0xffff0000, v76
v_lshlrev_b32 v50, 16, v77
v_and_b32 v51, 0xffff0000, v77
v_lshlrev_b32 v52, 16, v78
v_and_b32 v53, 0xffff0000, v78
v_lshlrev_b32 v54, 16, v79
v_and_b32 v55, 0xffff0000, v79
v_lshlrev_b32 v56, 16, v80
v_and_b32 v57, 0xffff0000, v80
v_lshlrev_b32 v58, 16, v81
v_and_b32 v59, 0xffff0000, v81
v_lshlrev_b32 v60, 16, v82
v_and_b32 v61, 0xffff0000, v82
v_lshlrev_b32 v62, 16, v83
v_and_b32 v63, 0xffff0000, v83
v_pk_add_f32 v[48:49], v[48:49], v[8:9]
v_pk_add_f32 v[50:51], v[50:51], v[10:11]
v_pk_add_f32 v[56:57], v[56:57], v[12:13]
v_pk_add_f32 v[58:59], v[58:59], v[14:15]
v_pk_add_f32 v[52:53], v[52:53], v[16:17]
v_pk_add_f32 v[54:55], v[54:55], v[18:19]
v_pk_add_f32 v[60:61], v[60:61], v[20:21]
v_pk_add_f32 v[62:63], v[62:63], v[22:23]
s_waitcnt lgkmcnt(0)
s_barrier
ds_read_b128 v[112:115], v7 offset:0
ds_read_b128 v[116:119], v7 offset:1024
ds_read_b128 v[120:123], v7 offset:2048
ds_read_b128 v[124:127], v7 offset:3072
s_waitcnt lgkmcnt(0)
v_pk_add_f32 v[48:49], v[48:49], v[112:113]
v_pk_add_f32 v[50:51], v[50:51], v[114:115]
v_pk_add_f32 v[56:57], v[56:57], v[116:117]
v_pk_add_f32 v[58:59], v[58:59], v[118:119]
v_pk_add_f32 v[52:53], v[52:53], v[120:121]
v_pk_add_f32 v[54:55], v[54:55], v[122:123]
v_pk_add_f32 v[60:61], v[60:61], v[124:125]
v_pk_add_f32 v[62:63], v[62:63], v[126:127]
v_pk_add_f32 v[128:129], v[48:49], v[50:51]
v_pk_mul_f32 v[130:131], v[48:49], v[48:49]
v_pk_mul_f32 v[132:133], v[48:49], v[88:89]
v_pk_add_f32 v[134:135], v[56:57], v[58:59]
v_pk_mul_f32 v[136:137], v[56:57], v[56:57]
v_pk_mul_f32 v[138:139], v[56:57], v[88:89]
v_pk_fma_f32 v[130:131], v[50:51], v[50:51], v[130:131]
v_pk_fma_f32 v[132:133], v[50:51], v[90:91], v[132:133]
v_pk_fma_f32 v[136:137], v[58:59], v[58:59], v[136:137]
v_pk_fma_f32 v[138:139], v[58:59], v[90:91], v[138:139]
v_pk_add_f32 v[128:129], v[128:129], v[52:53]
v_pk_fma_f32 v[130:131], v[52:53], v[52:53], v[130:131]
v_pk_fma_f32 v[132:133], v[52:53], v[92:93], v[132:133]
v_pk_add_f32 v[134:135], v[134:135], v[60:61]
v_pk_fma_f32 v[136:137], v[60:61], v[60:61], v[136:137]
v_pk_fma_f32 v[138:139], v[60:61], v[92:93], v[138:139]
v_pk_add_f32 v[128:129], v[128:129], v[54:55]
v_pk_fma_f32 v[130:131], v[54:55], v[54:55], v[130:131]
v_pk_fma_f32 v[132:133], v[54:55], v[94:95], v[132:133]
v_pk_add_f32 v[134:135], v[134:135], v[62:63]
v_pk_fma_f32 v[136:137], v[62:63], v[62:63], v[136:137]
v_pk_fma_f32 v[138:139], v[62:63], v[94:95], v[138:139]
v_add_f32 v64, v128, v129
v_add_f32 v65, v130, v131
v_add_f32 v66, v132, v133
v_add_f32 v68, v134, v135
v_add_f32 v69, v136, v137
v_add_f32 v70, v138, v139
v_permlane16_swap_b32 v64, v68
v_permlane16_swap_b32 v65, v69
v_permlane16_swap_b32 v66, v70
v_add_f32 v64, v64, v68
v_add_f32 v65, v65, v69
v_add_f32 v66, v66, v70
v_mov_b32 v68, v64
s_nop 1
v_permlane32_swap_b32 v64, v68
v_add_f32 v64, v64, v68
v_mov_b32 v69, v65
s_nop 1
v_permlane32_swap_b32 v65, v69
v_add_f32 v65, v65, v69
v_mov_b32 v70, v66
s_nop 1
v_permlane32_swap_b32 v66, v70
v_add_f32 v66, v66, v70
v_mov_b32 v67, s77
s_lshl_b32 s86, s80, 10
s_lshl_b32 s87, s81, 9
s_add_u32 s88, s86, s87
s_add_u32 s88, s88, 0
v_and_b32 v6, 31, v1
v_lshl_add_u32 v7, v6, 4, s88
ds_write_b128 v7, v[64:67]
s_waitcnt lgkmcnt(0)
s_barrier
s_cmp_eq_u32 s81, 0
s_cbranch_scc1 L_gather_24
s_and_b32 s86, s72, 3
s_lshl_b32 s86, s86, 13
v_lshl_add_u32 v5, v1, 4, s86
v_add_u32 v4, 98304, v5
v_add_u32 v5, 32768, v5
ds_write_b128 v4, v[160:163] offset:0
ds_write_b128 v4, v[164:167] offset:1024
ds_write_b128 v4, v[168:171] offset:2048
ds_write_b128 v4, v[172:175] offset:3072
ds_write_b128 v4, v[176:179] offset:4096
ds_write_b128 v4, v[180:183] offset:5120
ds_write_b128 v4, v[184:187] offset:6144
ds_write_b128 v4, v[188:191] offset:7168
s_waitcnt lgkmcnt(0)
s_branch L_gatherj_25
L_gather_24:
ds_read_b128 v[132:135], v7 offset:512
s_lshl_b32 s86, s75, 4
s_add_u32 s86, s86, s76
s_lshl_b32 s86, s86, 7
s_lshl_b32 s87, s80, 5
s_add_u32 s86, s86, s87
s_lshl_b32 s86, s86, 4
s_add_u32 s86, s86, 13107200
v_lshl_add_u32 v6, v6, 4, s86
s_waitcnt lgkmcnt(0)
v_add_f32 v64, v64, v132
v_add_f32 v65, v65, v133
v_add_f32 v66, v66, v134
v_cmp_gt_u32 vcc, 32, v1
s_nop 1
s_and_saveexec_b64 s[96:97], vcc
buffer_store_dwordx4 v[64:67], v6, s[44:47], 0 offen sc1
s_mov_b64 exec, s[96:97]
s_lshl_b32 s86, s75, 4
s_lshl_b32 s86, s86, 7
s_lshl_b32 s87, s80, 5
s_add_u32 s86, s86, s87
s_lshl_b32 s86, s86, 4
s_add_u32 s86, s86, 13107200
v_lshrrev_b32 v6, 5, v1
v_lshlrev_b32 v6, 11, v6
v_and_b32 v7, 31, v1
v_lshl_add_u32 v6, v7, 4, v6
v_add_u32 v6, s86, v6
s_mov_b32 s90, 0
L_s2poll_26:
s_mov_b32 s87, 0
buffer_load_dwordx4 v[128:131], v6, s[44:47], s87 offen sc1
s_mov_b32 s87, 4096
buffer_load_dwordx4 v[132:135], v6, s[44:47], s87 offen sc1
s_mov_b32 s87, 8192
buffer_load_dwordx4 v[136:139], v6, s[44:47], s87 offen sc1
s_mov_b32 s87, 12288
buffer_load_dwordx4 v[140:143], v6, s[44:47], s87 offen sc1
s_mov_b32 s87, 16384
buffer_load_dwordx4 v[144:147], v6, s[44:47], s87 offen sc1
s_mov_b32 s87, 20480
buffer_load_dwordx4 v[148:151], v6, s[44:47], s87 offen sc1
s_mov_b32 s87, 24576
buffer_load_dwordx4 v[152:155], v6, s[44:47], s87 offen sc1
s_mov_b32 s87, 28672
buffer_load_dwordx4 v[156:159], v6, s[44:47], s87 offen sc1
s_cmp_lg_u32 s90, 0
s_cbranch_scc1 L_nowrite_28
s_and_b32 s86, s72, 3
s_lshl_b32 s86, s86, 13
v_lshl_add_u32 v5, v1, 4, s86
v_add_u32 v4, 98304, v5
v_add_u32 v5, 32768, v5
ds_write_b128 v4, v[160:163] offset:32768
ds_write_b128 v4, v[164:167] offset:33792
ds_write_b128 v4, v[168:171] offset:34816
ds_write_b128 v4, v[172:175] offset:35840
ds_write_b128 v4, v[176:179] offset:36864
ds_write_b128 v4, v[180:183] offset:37888
ds_write_b128 v4, v[184:187] offset:38912
ds_write_b128 v4, v[188:191] offset:39936
ds_write_b128 v5, v[192:195] offset:0
ds_write_b128 v5, v[196:199] offset:1024
ds_write_b128 v5, v[200:203] offset:2048
ds_write_b128 v5, v[204:207] offset:3072
ds_write_b128 v5, v[208:211] offset:4096
ds_write_b128 v5, v[212:215] offset:5120
ds_write_b128 v5, v[216:219] offset:6144
ds_write_b128 v5, v[220:223] offset:7168
L_nowrite_28:
s_waitcnt vmcnt(0)
v_cmp_ne_u32 vcc, s77, v131
v_cmp_ne_u32 s[88:89], s77, v135
s_nop 1
s_or_b64 vcc, vcc, s[88:89]
v_cmp_ne_u32 s[88:89], s77, v139
s_nop 1
s_or_b64 vcc, vcc, s[88:89]
v_cmp_ne_u32 s[88:89], s77, v143
s_nop 1
s_or_b64 vcc, vcc, s[88:89]
v_cmp_ne_u32 s[88:89], s77, v147
s_nop 1
s_or_b64 vcc, vcc, s[88:89]
v_cmp_ne_u32 s[88:89], s77, v151
s_nop 1
s_or_b64 vcc, vcc, s[88:89]
v_cmp_ne_u32 s[88:89], s77, v155
s_nop 1
s_or_b64 vcc, vcc, s[88:89]
v_cmp_ne_u32 s[88:89], s77, v159
s_nop 1
s_or_b64 vcc, vcc, s[88:89]
s_cbranch_vccz L_s2ok_27
s_add_u32 s90, s90, 1
s_cmp_gt_u32 s90, 200000
s_cbranch_scc1 L_s2ok_27
s_branch L_s2poll_26
L_s2ok_27:
v_add_f32 v128, v128, v144
v_add_f32 v129, v129, v145
v_add_f32 v130, v130, v146
v_add_f32 v132, v132, v148
v_add_f32 v133, v133, v149
v_add_f32 v134, v134, v150
v_add_f32 v136, v136, v152
v_add_f32 v137, v137, v153
v_add_f32 v138, v138, v154
v_add_f32 v140, v140, v156
v_add_f32 v141, v141, v157
v_add_f32 v142, v142, v158
v_add_f32 v128, v128, v136
v_add_f32 v129, v129, v137
v_add_f32 v130, v130, v138
v_add_f32 v132, v132, v140
v_add_f32 v133, v133, v141
v_add_f32 v134, v134, v142
v_add_f32 v128, v128, v132
v_add_f32 v129, v129, v133
v_add_f32 v130, v130, v134
v_mov_b32 v132, v128
s_nop 1
v_permlane32_swap_b32 v128, v132
v_add_f32 v128, v128, v132
v_mov_b32 v133, v129
s_nop 1
v_permlane32_swap_b32 v129, v133
v_add_f32 v129, v129, v133
v_mov_b32 v134, v130
s_nop 1
v_permlane32_swap_b32 v130, v134
v_add_f32 v130, v130, v134
s_mov_b32 s88, 0x3a800000
s_mov_b32 s89, 0x3727c5ac
v_mul_f32 v128, s88, v128
v_mul_f32 v129, s88, v129
v_fma_f32 v129, -v128, v128, v129
v_max_f32 v129, 0, v129
v_cvt_pk_bf16_f32 v132, v129, v129
v_lshlrev_b32 v129, 16, v132
v_cvt_pk_bf16_f32 v133, v128, v128
v_lshlrev_b32 v128, 16, v133
v_add_f32 v129, s89, v129
v_cvt_pk_bf16_f32 v132, v129, v129
v_lshlrev_b32 v129, 16, v132
v_sqrt_f32 v129, v129
s_nop 0
v_cvt_pk_bf16_f32 v132, v129, v129
v_lshlrev_b32 v129, 16, v132
v_rcp_f32 v129, v129
v_fma_f32 v130, -v128, v96, v130
v_mul_f32 v130, v130, v129
v_mul_f32 v128, v128, v129
v_sub_f32 v133, 0, v128
v_mov_b32 v132, v129
v_mov_b32 v134, v130
s_lshl_b32 s86, s80, 9
s_add_u32 s88, s86, 4096
v_lshl_add_u32 v7, v7, 4, s88
ds_write_b128 v7, v[132:135]
s_waitcnt lgkmcnt(0)
L_gatherj_25:
s_barrier
s_lshl_b32 s86, s80, 9
s_add_u32 s86, s86, 4096
v_and_b32 v6, 15, v1
v_lshl_add_u32 v6, v6, 4, s86
v_lshlrev_b32 v7, 4, v1
v_add_u32 v7, 4096, v7
ds_read_b32 v128, v7 offset:8
ds_read_b32 v129, v7 offset:1032
ds_read_b128 v[64:67], v6 offset:0
ds_read_b128 v[68:71], v6 offset:256
s_waitcnt lgkmcnt(0)
v_ashrrev_i32 v135, 31, v128
v_or_b32 v135, 0x80000000, v135
v_xor_b32 v130, v128, v135
v_ashrrev_i32 v135, 31, v129
v_or_b32 v135, 0x80000000, v135
v_xor_b32 v131, v129, v135
v_sub_u32 v135, 127, v1
s_movk_i32 s88, 0xff80
v_and_or_b32 v130, v130, s88, v135
v_subrev_u32 v135, 64, v135
v_and_or_b32 v131, v131, s88, v135
v_max_u32 v132, v130, v131
v_min_u32 v133, v130, v131
v_mov_b32 v134, v132
s_nop 1
v_max_u32_dpp v134, v134, v134 quad_perm:[1,0,3,2] row_mask:0xf bank_mask:0xf
s_nop 1
v_max_u32_dpp v134, v134, v134 quad_perm:[2,3,0,1] row_mask:0xf bank_mask:0xf
s_nop 1
v_max_u32_dpp v134, v134, v134 row_half_mirror row_mask:0xf bank_mask:0xf
s_nop 1
v_max_u32_dpp v134, v134, v134 row_mirror row_mask:0xf bank_mask:0xf
v_mov_b32 v135, v134
s_nop 1
v_permlane16_swap_b32 v134, v135
v_max_u32 v134, v134, v135
v_mov_b32 v135, v134
s_nop 1
v_permlane32_swap_b32 v134, v135
v_max_u32 v134, v134, v135
v_cmp_eq_u32 vcc, v134, v132
s_nop 1
v_cndmask_b32 v132, v132, v133, vcc
s_nop 1
v_max_u32_dpp v132, v132, v132 quad_perm:[1,0,3,2] row_mask:0xf bank_mask:0xf
s_nop 1
v_max_u32_dpp v132, v132, v132 quad_perm:[2,3,0,1] row_mask:0xf bank_mask:0xf
s_nop 1
v_max_u32_dpp v132, v132, v132 row_half_mirror row_mask:0xf bank_mask:0xf
s_nop 1
v_max_u32_dpp v132, v132, v132 row_mirror row_mask:0xf bank_mask:0xf
v_mov_b32 v135, v132
s_nop 1
v_permlane16_swap_b32 v132, v135
v_max_u32 v132, v132, v135
v_mov_b32 v135, v132
s_nop 1
v_permlane32_swap_b32 v132, v135
v_max_u32 v132, v132, v135
v_readfirstlane_b32 s82, v134
v_readfirstlane_b32 s83, v132
s_nop 0
s_and_b32 s82, s82, 127
s_sub_u32 s82, 127, s82
s_and_b32 s83, s83, 127
s_sub_u32 s83, 127, s83
s_cmp_lg_u32 s76, 0
s_cbranch_scc1 L_nocand_29
s_cmp_lg_u32 s72, 0
s_cbranch_scc1 L_nocand_29
s_lshl_b32 s86, s82, 4
s_add_u32 s86, s86, 4104
v_mov_b32 v6, s86
ds_read_b32 v136, v6
s_lshl_b32 s86, s83, 4
s_add_u32 s86, s86, 4104
v_mov_b32 v7, s86
ds_read_b32 v137, v7
s_lshl_b32 s86, s75, 7
s_add_u32 s87, s86, s82
s_add_u32 s88, s86, s83
s_lshl_b32 s88, s88, 16
s_or_b32 s87, s87, s88
v_mov_b32 v138, s87
v_mov_b32 v139, s77
s_lshl_b32 s86, s75, 6
s_add_u32 s86, s86, 13631488
v_mov_b32 v6, s86
s_waitcnt lgkmcnt(0)
v_cmp_eq_u32 vcc, 0, v1
s_nop 1
s_and_saveexec_b64 s[96:97], vcc
buffer_store_dwordx4 v[136:139], v6, s[44:47], 0 offen sc1
s_mov_b64 exec, s[96:97]
L_nocand_29:
v_lshrrev_b32 v2, 4, v1
v_and_b32 v4, 15, v1
s_mov_b32 s88, 0x05040100
s_mov_b32 s89, 0x07060302
s_lshr_b32 s86, s82, 5
s_cmp_lg_u32 s86, s80
s_cbranch_scc1 L_crskip_30
s_bitcmp1_b32 s82, 4
s_cbranch_scc1 L_crb1_31
v_pk_fma_f32 v[156:157], v[48:49], v[64:65], v[64:65] op_sel:[0,0,1] op_sel_hi:[1,0,1]
v_pk_fma_f32 v[158:159], v[50:51], v[64:65], v[64:65] op_sel:[0,0,1] op_sel_hi:[1,0,1]
v_pk_fma_f32 v[160:161], v[52:53], v[64:65], v[64:65] op_sel:[0,0,1] op_sel_hi:[1,0,1]
v_pk_fma_f32 v[162:163], v[54:55], v[64:65], v[64:65] op_sel:[0,0,1] op_sel_hi:[1,0,1]
v_cvt_pk_bf16_f32 v164, v48, v49
v_cvt_pk_bf16_f32 v168, v156, v157
v_cvt_pk_bf16_f32 v165, v50, v51
v_cvt_pk_bf16_f32 v169, v158, v159
v_cvt_pk_bf16_f32 v166, v52, v53
v_cvt_pk_bf16_f32 v170, v160, v161
v_cvt_pk_bf16_f32 v167, v54, v55
v_cvt_pk_bf16_f32 v171, v162, v163
v_perm_b32 v140, v168, v164, s88
v_perm_b32 v142, v168, v164, s89
v_mov_b32 v141, s77
v_mov_b32 v143, s77
v_perm_b32 v144, v169, v165, s88
v_perm_b32 v146, v169, v165, s89
v_mov_b32 v145, s77
v_mov_b32 v147, s77
v_perm_b32 v148, v170, v166, s88
v_perm_b32 v150, v170, v166, s89
v_mov_b32 v149, s77
v_mov_b32 v151, s77
v_perm_b32 v152, v171, v167, s88
v_perm_b32 v154, v171, v167, s89
v_mov_b32 v153, s77
v_mov_b32 v155, s77
s_branch L_crst_32
L_crb1_31:
v_pk_fma_f32 v[156:157], v[56:57], v[68:69], v[68:69] op_sel:[0,0,1] op_sel_hi:[1,0,1]
v_pk_fma_f32 v[158:159], v[58:59], v[68:69], v[68:69] op_sel:[0,0,1] op_sel_hi:[1,0,1]
v_pk_fma_f32 v[160:161], v[60:61], v[68:69], v[68:69] op_sel:[0,0,1] op_sel_hi:[1,0,1]
v_pk_fma_f32 v[162:163], v[62:63], v[68:69], v[68:69] op_sel:[0,0,1] op_sel_hi:[1,0,1]
v_cvt_pk_bf16_f32 v164, v56, v57
v_cvt_pk_bf16_f32 v168, v156, v157
v_cvt_pk_bf16_f32 v165, v58, v59
v_cvt_pk_bf16_f32 v169, v158, v159
v_cvt_pk_bf16_f32 v166, v60, v61
v_cvt_pk_bf16_f32 v170, v160, v161
v_cvt_pk_bf16_f32 v167, v62, v63
v_cvt_pk_bf16_f32 v171, v162, v163
v_perm_b32 v140, v168, v164, s88
v_perm_b32 v142, v168, v164, s89
v_mov_b32 v141, s77
v_mov_b32 v143, s77
v_perm_b32 v144, v169, v165, s88
v_perm_b32 v146, v169, v165, s89
v_mov_b32 v145, s77
v_mov_b32 v147, s77
v_perm_b32 v148, v170, v166, s88
v_perm_b32 v150, v170, v166, s89
v_mov_b32 v149, s77
v_mov_b32 v151, s77
v_perm_b32 v152, v171, v167, s88
v_perm_b32 v154, v171, v167, s89
v_mov_b32 v153, s77
v_mov_b32 v155, s77
L_crst_32:
s_lshl_b32 s86, s75, 1
s_add_u32 s86, s86, 0
s_lshl_b32 s86, s86, 10
s_lshl_b32 s87, s76, 6
s_add_u32 s86, s86, s87
s_lshl_b32 s87, s81, 5
s_add_u32 s86, s86, s87
s_lshl_b32 s86, s86, 3
s_add_u32 s86, s86, 13697024
v_lshl_add_u32 v6, v2, 5, s86
s_and_b32 s87, s82, 15
v_cmp_eq_u32 vcc, s87, v4
s_nop 1
s_and_saveexec_b64 s[96:97], vcc
buffer_store_dwordx4 v[140:143], v6, s[44:47], 0 offen offset:0 sc1
buffer_store_dwordx4 v[144:147], v6, s[44:47], 0 offen offset:16 sc1
buffer_store_dwordx4 v[148:151], v6, s[44:47], 0 offen offset:128 sc1
buffer_store_dwordx4 v[152:155], v6, s[44:47], 0 offen offset:144 sc1
s_mov_b64 exec, s[96:97]
L_crskip_30:
s_lshr_b32 s86, s83, 5
s_cmp_lg_u32 s86, s80
s_cbranch_scc1 L_crskip_33
s_bitcmp1_b32 s83, 4
s_cbranch_scc1 L_crb1_34
v_pk_fma_f32 v[156:157], v[48:49], v[64:65], v[64:65] op_sel:[0,0,1] op_sel_hi:[1,0,1]
v_pk_fma_f32 v[158:159], v[50:51], v[64:65], v[64:65] op_sel:[0,0,1] op_sel_hi:[1,0,1]
v_pk_fma_f32 v[160:161], v[52:53], v[64:65], v[64:65] op_sel:[0,0,1] op_sel_hi:[1,0,1]
v_pk_fma_f32 v[162:163], v[54:55], v[64:65], v[64:65] op_sel:[0,0,1] op_sel_hi:[1,0,1]
v_cvt_pk_bf16_f32 v164, v48, v49
v_cvt_pk_bf16_f32 v168, v156, v157
v_cvt_pk_bf16_f32 v165, v50, v51
v_cvt_pk_bf16_f32 v169, v158, v159
v_cvt_pk_bf16_f32 v166, v52, v53
v_cvt_pk_bf16_f32 v170, v160, v161
v_cvt_pk_bf16_f32 v167, v54, v55
v_cvt_pk_bf16_f32 v171, v162, v163
v_perm_b32 v140, v168, v164, s88
v_perm_b32 v142, v168, v164, s89
v_mov_b32 v141, s77
v_mov_b32 v143, s77
v_perm_b32 v144, v169, v165, s88
v_perm_b32 v146, v169, v165, s89
v_mov_b32 v145, s77
v_mov_b32 v147, s77
v_perm_b32 v148, v170, v166, s88
v_perm_b32 v150, v170, v166, s89
v_mov_b32 v149, s77
v_mov_b32 v151, s77
v_perm_b32 v152, v171, v167, s88
v_perm_b32 v154, v171, v167, s89
v_mov_b32 v153, s77
v_mov_b32 v155, s77
s_branch L_crst_35
L_crb1_34:
v_pk_fma_f32 v[156:157], v[56:57], v[68:69], v[68:69] op_sel:[0,0,1] op_sel_hi:[1,0,1]
v_pk_fma_f32 v[158:159], v[58:59], v[68:69], v[68:69] op_sel:[0,0,1] op_sel_hi:[1,0,1]
v_pk_fma_f32 v[160:161], v[60:61], v[68:69], v[68:69] op_sel:[0,0,1] op_sel_hi:[1,0,1]
v_pk_fma_f32 v[162:163], v[62:63], v[68:69], v[68:69] op_sel:[0,0,1] op_sel_hi:[1,0,1]
v_cvt_pk_bf16_f32 v164, v56, v57
v_cvt_pk_bf16_f32 v168, v156, v157
v_cvt_pk_bf16_f32 v165, v58, v59
v_cvt_pk_bf16_f32 v169, v158, v159
v_cvt_pk_bf16_f32 v166, v60, v61
v_cvt_pk_bf16_f32 v170, v160, v161
v_cvt_pk_bf16_f32 v167, v62, v63
v_cvt_pk_bf16_f32 v171, v162, v163
v_perm_b32 v140, v168, v164, s88
v_perm_b32 v142, v168, v164, s89
v_mov_b32 v141, s77
v_mov_b32 v143, s77
v_perm_b32 v144, v169, v165, s88
v_perm_b32 v146, v169, v165, s89
v_mov_b32 v145, s77
v_mov_b32 v147, s77
v_perm_b32 v148, v170, v166, s88
v_perm_b32 v150, v170, v166, s89
v_mov_b32 v149, s77
v_mov_b32 v151, s77
v_perm_b32 v152, v171, v167, s88
v_perm_b32 v154, v171, v167, s89
v_mov_b32 v153, s77
v_mov_b32 v155, s77
L_crst_35:
s_lshl_b32 s86, s75, 1
s_add_u32 s86, s86, 1
s_lshl_b32 s86, s86, 10
s_lshl_b32 s87, s76, 6
s_add_u32 s86, s86, s87
s_lshl_b32 s87, s81, 5
s_add_u32 s86, s86, s87
s_lshl_b32 s86, s86, 3
s_add_u32 s86, s86, 13697024
v_lshl_add_u32 v6, v2, 5, s86
s_and_b32 s87, s83, 15
v_cmp_eq_u32 vcc, s87, v4
s_nop 1
s_and_saveexec_b64 s[96:97], vcc
buffer_store_dwordx4 v[140:143], v6, s[44:47], 0 offen offset:0 sc1
buffer_store_dwordx4 v[144:147], v6, s[44:47], 0 offen offset:16 sc1
buffer_store_dwordx4 v[148:151], v6, s[44:47], 0 offen offset:128 sc1
buffer_store_dwordx4 v[152:155], v6, s[44:47], 0 offen offset:144 sc1
s_mov_b64 exec, s[96:97]
L_crskip_33:
v_add_f32 v66, 1.0, v64
v_add_f32 v70, 1.0, v68
v_pk_fma_f32 v[128:129], v[48:49], v[66:67], v[64:65] op_sel:[0,0,1] op_sel_hi:[1,0,1]
v_pk_fma_f32 v[130:131], v[50:51], v[66:67], v[64:65] op_sel:[0,0,1] op_sel_hi:[1,0,1]
v_pk_fma_f32 v[132:133], v[52:53], v[66:67], v[64:65] op_sel:[0,0,1] op_sel_hi:[1,0,1]
v_pk_fma_f32 v[134:135], v[54:55], v[66:67], v[64:65] op_sel:[0,0,1] op_sel_hi:[1,0,1]
v_pk_fma_f32 v[136:137], v[56:57], v[70:71], v[68:69] op_sel:[0,0,1] op_sel_hi:[1,0,1]
v_pk_fma_f32 v[138:139], v[58:59], v[70:71], v[68:69] op_sel:[0,0,1] op_sel_hi:[1,0,1]
v_pk_fma_f32 v[140:141], v[60:61], v[70:71], v[68:69] op_sel:[0,0,1] op_sel_hi:[1,0,1]
v_pk_fma_f32 v[142:143], v[62:63], v[70:71], v[68:69] op_sel:[0,0,1] op_sel_hi:[1,0,1]
v_cvt_pk_bf16_f32 v112, v128, v129
v_cvt_pk_bf16_f32 v113, v130, v131
v_cvt_pk_bf16_f32 v114, v132, v133
v_cvt_pk_bf16_f32 v115, v134, v135
v_cvt_pk_bf16_f32 v116, v136, v137
v_cvt_pk_bf16_f32 v117, v138, v139
v_cvt_pk_bf16_f32 v118, v140, v141
v_cvt_pk_bf16_f32 v119, v142, v143
v_lshrrev_b32 v2, 4, v1
v_and_b32 v4, 15, v1
v_and_b32 v7, 1, v2
v_lshlrev_b32 v7, 5, v7
v_lshrrev_b32 v8, 1, v2
v_lshl_add_u32 v7, v8, 4, v7
s_lshl_b32 s86, s76, 7
s_lshl_b32 s87, s81, 6
s_add_u32 s86, s86, s87
v_add_u32 v7, s86, v7
s_lshl_b32 s87, s75, 7
s_lshl_b32 s88, s80, 5
s_add_u32 s87, s87, s88
v_add_u32 v8, s87, v4
v_lshl_add_u32 v7, v8, 11, v7
v_permlane16_swap_b32 v112, v114
v_permlane16_swap_b32 v113, v115
v_permlane16_swap_b32 v116, v118
v_permlane16_swap_b32 v117, v119
buffer_store_dwordx4 v[112:115], v7, s[48:51], 0 offen sc1
s_mov_b32 s87, 32768
buffer_store_dwordx4 v[116:119], v7, s[48:51], s87 offen sc1
s_cmp_lt_u32 s79, 224
s_cbranch_scc1 L_ffnwg_36
s_waitcnt vmcnt(0)
s_lshl_b32 s86, s75, 4
s_add_u32 s86, s86, s76
s_lshl_b32 s86, s86, 3
s_add_u32 s86, s86, s72
s_lshl_b32 s86, s86, 2
s_add_u32 s86, s86, 16318464
v_mov_b32 v6, s86
v_mov_b32 v7, s77
v_cmp_eq_u32 vcc, 0, v1
s_nop 1
s_and_saveexec_b64 s[96:97], vcc
buffer_store_dword v7, v6, s[44:47], 0 offen sc1
s_mov_b64 exec, s[96:97]
s_branch L_fin
L_ffnwg_36:
s_cmp_lt_u32 s72, 2
s_cbranch_scc1 L_sel01_38
s_branch L_selj_37
L_sel01_38:
v_and_b32 v6, 15, v1
v_lshlrev_b32 v6, 6, v6
v_add_u32 v6, 13631488, v6
s_mov_b32 s90, 0
buffer_load_dwordx4 v[136:139], v6, s[44:47], 0 offen sc1
s_branch L_cchk_41
L_cpoll_39:
buffer_load_dwordx4 v[136:139], v6, s[44:47], 0 offen sc1
L_cchk_41:
s_waitcnt vmcnt(0)
v_cmp_ne_u32 vcc, s77, v139
s_nop 1
s_cbranch_vccz L_cok_40
s_add_u32 s90, s90, 1
s_cmp_gt_u32 s90, 200000
s_cbranch_scc1 L_cok_40
s_branch L_cpoll_39
L_cok_40:
v_ashrrev_i32 v145, 31, v136
v_or_b32 v145, 0x80000000, v145
v_xor_b32 v140, v136, v145
v_ashrrev_i32 v145, 31, v137
v_or_b32 v145, 0x80000000, v145
v_xor_b32 v141, v137, v145
s_movk_i32 s88, 0xf800
s_movk_i32 s89, 0x7ff
v_and_b32 v145, 0xffff, v138
v_sub_u32 v145, s89, v145
v_and_or_b32 v140, v140, s88, v145
v_lshrrev_b32 v145, 16, v138
v_sub_u32 v145, s89, v145
v_and_or_b32 v141, v141, s88, v145
v_max_u32 v142, v140, v141
v_min_u32 v143, v140, v141
v_mov_b32 v144, v142
s_nop 1
v_max_u32_dpp v144, v144, v144 quad_perm:[1,0,3,2] row_mask:0xf bank_mask:0xf
s_nop 1
v_max_u32_dpp v144, v144, v144 quad_perm:[2,3,0,1] row_mask:0xf bank_mask:0xf
s_nop 1
v_max_u32_dpp v144, v144, v144 row_half_mirror row_mask:0xf bank_mask:0xf
s_nop 1
v_max_u32_dpp v144, v144, v144 row_mirror row_mask:0xf bank_mask:0xf
v_cmp_eq_u32 vcc, v144, v142
s_nop 1
v_cndmask_b32 v142, v142, v143, vcc
s_nop 1
v_max_u32_dpp v142, v142, v142 quad_perm:[1,0,3,2] row_mask:0xf bank_mask:0xf
s_nop 1
v_max_u32_dpp v142, v142, v142 quad_perm:[2,3,0,1] row_mask:0xf bank_mask:0xf
s_nop 1
v_max_u32_dpp v142, v142, v142 row_half_mirror row_mask:0xf bank_mask:0xf
s_nop 1
v_max_u32_dpp v142, v142, v142 row_mirror row_mask:0xf bank_mask:0xf
v_readfirstlane_b32 s86, v144
v_readfirstlane_b32 s87, v142
s_nop 0
s_and_b32 s86, s86, 0x7ff
s_sub_u32 s86, 0x7ff, s86
s_and_b32 s87, s87, 0x7ff
s_sub_u32 s87, 0x7ff, s87
s_lshr_b32 s88, s86, 7
v_readlane_b32 s89, v138, s88
v_readlane_b32 s93, v136, s88
v_readlane_b32 s95, v137, s88
s_and_b32 s89, s89, 0xffff
s_cmp_eq_u32 s89, s86
s_cselect_b32 s91, 0, 1
s_cselect_b32 s93, s93, s95
s_lshl_b32 s88, s88, 1
s_add_u32 s91, s91, s88
s_lshr_b32 s88, s87, 7
v_readlane_b32 s89, v138, s88
v_readlane_b32 s94, v136, s88
v_readlane_b32 s95, v137, s88
s_and_b32 s89, s89, 0xffff
s_cmp_eq_u32 s89, s87
s_cselect_b32 s92, 0, 1
s_cselect_b32 s94, s94, s95
s_lshl_b32 s88, s88, 1
s_add_u32 s92, s92, s88
s_cmp_eq_u32 s72, 0
s_cselect_b32 s88, s91, s92
s_lshl_b32 s88, s88, 13
s_and_b32 s89, s79, 3
s_lshl_b32 s89, s89, 11
s_add_u32 s88, s88, s89
s_add_u32 s88, s88, 13697024
v_lshl_add_u32 v6, v1, 4, s88
s_mov_b32 s90, 0
L_rpoll_42:
buffer_load_dwordx4 v[152:155], v6, s[44:47], 0 offen offset:0 sc1
buffer_load_dwordx4 v[156:159], v6, s[44:47], 0 offen offset:1024 sc1
v_mov_b32 v146, s86
v_mov_b32 v147, s87
v_mov_b32 v148, s93
v_mov_b32 v149, s94
v_mov_b32 v150, s91
v_mov_b32 v151, s92
v_mov_b32 v7, 12288
ds_write_b128 v7, v[146:149]
ds_write_b64 v7, v[150:151] offset:16
s_waitcnt vmcnt(0)
v_cmp_ne_u32 vcc, s77, v153
v_cmp_ne_u32 s[88:89], s77, v155
s_nop 1
s_or_b64 vcc, vcc, s[88:89]
v_cmp_ne_u32 s[88:89], s77, v157
s_nop 1
s_or_b64 vcc, vcc, s[88:89]
v_cmp_ne_u32 s[88:89], s77, v159
s_nop 1
s_or_b64 vcc, vcc, s[88:89]
s_cbranch_vccz L_rok_43
s_add_u32 s90, s90, 1
s_cmp_gt_u32 s90, 200000
s_cbranch_scc1 L_rok_43
s_branch L_rpoll_42
L_rok_43:
s_lshl_b32 s89, s72, 9
s_add_u32 s89, s89, 16384
s_mov_b32 s88, 0x07060302
v_lshl_add_u32 v6, v1, 2, s89
v_perm_b32 v152, v154, v152, s88
v_perm_b32 v156, v158, v156, s88
ds_write_b32 v6, v152 offset:0
ds_write_b32 v6, v156 offset:256
s_cmp_lg_u32 s78, 0
s_cbranch_scc1 L_nononce_44
s_cmp_lg_u32 s72, 0
s_cbranch_scc1 L_nononce_44
v_mov_b32 v6, 16384000
v_mov_b32 v7, s77
v_cmp_eq_u32 vcc, 0, v1
s_nop 1
s_and_saveexec_b64 s[96:97], vcc
buffer_store_dword v7, v6, s[44:47], 0 offen sc1
s_mov_b64 exec, s[96:97]
L_nononce_44:
L_selj_37:
s_waitcnt vmcnt(0) lgkmcnt(0)
s_barrier
s_lshl_b32 s86, s75, 4
s_add_u32 s86, s86, s76
s_lshl_b32 s86, s86, 3
s_add_u32 s86, s86, s72
s_lshl_b32 s86, s86, 2
s_add_u32 s86, s86, 16318464
v_mov_b32 v6, s86
v_mov_b32 v7, s77
v_cmp_eq_u32 vcc, 0, v1
s_nop 1
s_and_saveexec_b64 s[96:97], vcc
buffer_store_dword v7, v6, s[44:47], 0 offen sc1
s_mov_b64 exec, s[96:97]
v_lshrrev_b32 v2, 4, v1
v_and_b32 v4, 15, v1
v_and_b32 v6, 1, v4
v_lshlrev_b32 v6, 9, v6
v_lshl_add_u32 v6, v2, 4, v6
v_add_u32 v6, 16384, v6
ds_read_b128 v[8:11], v6 offset:0
ds_read_b128 v[12:15], v6 offset:64
ds_read_b128 v[16:19], v6 offset:128
ds_read_b128 v[20:23], v6 offset:192
ds_read_b128 v[24:27], v6 offset:256
ds_read_b128 v[28:31], v6 offset:320
ds_read_b128 v[32:35], v6 offset:384
ds_read_b128 v[36:39], v6 offset:448
s_and_b32 s86, s72, 3
s_lshl_b32 s86, s86, 5
v_and_b32 v5, 3, v4
v_lshl_add_u32 v5, v5, 3, s86
v_bfe_u32 v7, v4, 3, 1
v_lshlrev_b32 v7, 6, v7
v_xor_b32 v5, v5, v7
v_and_b32 v7, 1, v2
v_lshlrev_b32 v7, 5, v7
v_xor_b32 v5, v5, v7
v_lshrrev_b32 v7, 2, v4
v_lshl_add_u32 v7, v2, 3, v7
v_lshl_add_u32 v7, v7, 7, v5
s_lshr_b32 s86, s72, 2
s_lshl_b32 s86, s86, 15
s_add_u32 s86, s86, 98304
v_add_u32 v7, s86, v7
ds_read_b64_tr_b16 v[40:41], v7 offset:0
ds_read_b64_tr_b16 v[42:43], v7 offset:512
ds_read_b64_tr_b16 v[44:45], v7 offset:4096
ds_read_b64_tr_b16 v[46:47], v7 offset:4608
ds_read_b64_tr_b16 v[48:49], v7 offset:8192
ds_read_b64_tr_b16 v[50:51], v7 offset:8704
ds_read_b64_tr_b16 v[52:53], v7 offset:12288
ds_read_b64_tr_b16 v[54:55], v7 offset:12800
ds_read_b64_tr_b16 v[56:57], v7 offset:16384
ds_read_b64_tr_b16 v[58:59], v7 offset:16896
ds_read_b64_tr_b16 v[60:61], v7 offset:20480
ds_read_b64_tr_b16 v[62:63], v7 offset:20992
ds_read_b64_tr_b16 v[64:65], v7 offset:24576
ds_read_b64_tr_b16 v[66:67], v7 offset:25088
ds_read_b64_tr_b16 v[68:69], v7 offset:28672
ds_read_b64_tr_b16 v[70:71], v7 offset:29184
s_lshl_b32 s86, s79, 10
s_lshl_b32 s87, s72, 7
s_add_u32 s86, s86, s87
s_add_u32 s86, s86, 14680064
v_lshlrev_b32 v6, 6, v4
v_lshl_add_u32 v6, v2, 4, v6
v_add_u32 v6, s86, v6
s_waitcnt lgkmcnt(14)
v_mfma_f32_16x16x32_bf16 v[72:75], v[40:43], v[8:11], 0
s_waitcnt lgkmcnt(12)
v_mfma_f32_16x16x32_bf16 v[76:79], v[44:47], v[12:15], 0
s_waitcnt lgkmcnt(10)
v_mfma_f32_16x16x32_bf16 v[72:75], v[48:51], v[16:19], v[72:75]
s_waitcnt lgkmcnt(8)
v_mfma_f32_16x16x32_bf16 v[76:79], v[52:55], v[20:23], v[76:79]
s_waitcnt lgkmcnt(6)
v_mfma_f32_16x16x32_bf16 v[72:75], v[56:59], v[24:27], v[72:75]
s_waitcnt lgkmcnt(4)
v_mfma_f32_16x16x32_bf16 v[76:79], v[60:63], v[28:31], v[76:79]
s_waitcnt lgkmcnt(2)
v_mfma_f32_16x16x32_bf16 v[72:75], v[64:67], v[32:35], v[72:75]
s_waitcnt lgkmcnt(0)
v_mfma_f32_16x16x32_bf16 v[76:79], v[68:71], v[36:39], v[76:79]
s_nop 7
v_pk_add_f32 v[72:73], v[72:73], v[76:77]
v_pk_add_f32 v[74:75], v[74:75], v[78:79]
s_mov_b32 s88, 0x7fc00000
v_mov_b32 v5, s88
v_cmp_eq_u32 vcc, -1, v72
s_nop 1
v_cndmask_b32 v72, v72, v5, vcc
v_cmp_eq_u32 vcc, -1, v73
s_nop 1
v_cndmask_b32 v73, v73, v5, vcc
v_cmp_eq_u32 vcc, -1, v74
s_nop 1
v_cndmask_b32 v74, v74, v5, vcc
v_cmp_eq_u32 vcc, -1, v75
s_nop 1
v_cndmask_b32 v75, v75, v5, vcc
v_cmp_gt_u32 vcc, 2, v4
s_nop 1
s_and_saveexec_b64 s[96:97], vcc
buffer_store_dwordx4 v[72:75], v6, s[44:47], 0 offen sc1
s_mov_b64 exec, s[96:97]
v_lshrrev_b32 v7, 5, v1
v_lshlrev_b32 v7, 3, v7
v_lshrrev_b32 v5, 2, v4
v_add_u32 v7, v7, v5
v_lshlrev_b32 v7, 9, v7
v_bfe_u32 v5, v1, 4, 1
v_lshl_add_u32 v7, v5, 5, v7
v_and_b32 v5, 3, v4
v_lshl_add_u32 v7, v5, 3, v7
s_lshl_b32 s86, s72, 6
s_add_u32 s86, s86, 32768
v_add_u32 v7, s86, v7
v_mov_b32 v99, v7
ds_read_b64_tr_b16 v[8:9], v99 offset:0
ds_read_b64_tr_b16 v[10:11], v99 offset:2048
ds_read_b64_tr_b16 v[12:13], v99 offset:8192
ds_read_b64_tr_b16 v[14:15], v99 offset:10240
ds_read_b64_tr_b16 v[16:17], v99 offset:16384
ds_read_b64_tr_b16 v[18:19], v99 offset:18432
ds_read_b64_tr_b16 v[20:21], v99 offset:24576
ds_read_b64_tr_b16 v[22:23], v99 offset:26624
s_cmp_lg_u32 s72, 1
s_cbranch_scc1 L_notw0_45
s_lshr_b32 s86, s78, 3
s_cmp_ge_u32 s86, 8
s_cbranch_scc1 L_notw0_45
s_and_b32 s87, s78, 7
s_lshl_b32 s87, s87, 3
s_add_u32 s86, s86, s87
s_lshr_b32 s80, s86, 5
s_and_b32 s81, s86, 31
v_mov_b32 v7, 12288
ds_read_b128 v[100:103], v7
ds_read_b64 v[104:105], v7 offset:16
s_waitcnt lgkmcnt(0)
v_readfirstlane_b32 s82, v100
v_readfirstlane_b32 s87, v101
v_readfirstlane_b32 s83, v102
v_readfirstlane_b32 s89, v103
v_readfirstlane_b32 s91, v104
v_readfirstlane_b32 s92, v105
s_cmp_eq_u32 s80, 0
s_cselect_b32 s82, s82, s87
s_cselect_b32 s83, s83, s89
s_cselect_b32 s91, s91, s92
s_lshl_b32 s91, s91, 13
s_lshl_b32 s87, s81, 8
s_add_u32 s91, s91, s87
s_add_u32 s91, s91, 13697024
v_and_b32 v7, 31, v1
v_lshl_add_u32 v7, v7, 3, s91
v_mov_b32 v115, v7
s_lshr_b32 s87, s82, 7
s_lshl_b32 s87, s87, 4
s_lshr_b32 s89, s81, 1
s_add_u32 s87, s87, s89
s_lshl_b32 s87, s87, 3
s_bfe_u32 s89, s82, 0x20005
s_add_u32 s87, s87, s89
s_and_b32 s89, s81, 1
s_lshl_b32 s89, s89, 2
s_add_u32 s87, s87, s89
s_lshl_b32 s87, s87, 2
s_add_u32 s87, s87, 16318464
v_mov_b32 v108, s87
s_mov_b32 s90, 0
L_fpoll_46:
buffer_load_dwordx2 v[106:107], v115, s[44:47], 0 offen sc1
buffer_load_dword v109, v108, s[44:47], 0 offen sc1
s_waitcnt vmcnt(0)
v_cmp_ne_u32 vcc, s77, v109
v_cmp_ne_u32 s[88:89], s77, v107
s_nop 1
s_or_b64 vcc, vcc, s[88:89]
s_cbranch_vccz L_fok_47
s_add_u32 s90, s90, 1
s_cmp_gt_u32 s90, 200000
s_cbranch_scc1 L_fok_47
s_branch L_fpoll_46
L_fok_47:
v_mov_b32 v110, s83
v_cvt_pk_bf16_f32 v111, v110, v110
v_lshlrev_b32 v110, 16, v111
v_mul_f32 v111, 0xbfb8aa3b, v110
v_exp_f32 v111, v111
s_nop 0
v_add_f32 v111, 1.0, v111
v_rcp_f32 v110, v111
s_nop 0
v_cvt_pk_bf16_f32 v111, v110, v110
v_lshlrev_b32 v110, 16, v111
v_and_b32 v112, 0xffff0000, v106
v_lshlrev_b32 v113, 16, v106
s_lshl_b32 s86, s82, 11
s_lshl_b32 s87, s81, 6
s_add_u32 s86, s86, s87
v_and_b32 v114, 31, v1
v_lshl_add_u32 v114, v114, 1, s86
L_notw0_45:
s_cmp_lg_u32 s72, 0
s_cbranch_scc1 L_actj_48
s_and_b32 s86, s79, 0xfffc
s_lshl_b32 s86, s86, 10
s_add_u32 s86, s86, 14680064
v_lshl_add_u32 v6, v1, 4, s86
s_mov_b32 s90, 0
L_ppoll_49:
buffer_load_dwordx4 v[80:83], v6, s[44:47], 0 offen offset:0 sc1
buffer_load_dwordx4 v[84:87], v6, s[44:47], 0 offen offset:1024 sc1
buffer_load_dwordx4 v[88:91], v6, s[44:47], 0 offen offset:2048 sc1
buffer_load_dwordx4 v[92:95], v6, s[44:47], 0 offen offset:3072 sc1
s_waitcnt vmcnt(0)
v_max3_u32 v7, v80, v81, v82
v_max3_u32 v5, v83, v84, v85
v_max3_u32 v7, v7, v86, v87
v_max3_u32 v5, v5, v88, v89
v_max3_u32 v7, v7, v90, v91
v_max3_u32 v5, v5, v92, v93
v_max3_u32 v7, v7, v94, v95
v_max_u32 v7, v7, v5
v_cmp_eq_u32 vcc, -1, v7
s_nop 1
s_cbranch_vccz L_pok_50
s_add_u32 s90, s90, 1
s_cmp_gt_u32 s90, 200000
s_cbranch_scc1 L_pok_50
s_branch L_ppoll_49
L_pok_50:
v_pk_add_f32 v[80:81], v[80:81], v[84:85]
v_pk_add_f32 v[88:89], v[88:89], v[92:93]
v_pk_add_f32 v[82:83], v[82:83], v[86:87]
v_pk_add_f32 v[90:91], v[90:91], v[94:95]
v_pk_add_f32 v[80:81], v[80:81], v[88:89]
v_pk_add_f32 v[82:83], v[82:83], v[90:91]
v_cvt_pk_bf16_f32 v84, v80, v81
v_cvt_pk_bf16_f32 v85, v82, v83
v_lshlrev_b32 v80, 16, v84
v_and_b32 v81, 0xffff0000, v84
v_lshlrev_b32 v82, 16, v85
v_and_b32 v83, 0xffff0000, v85
v_mov_b32 v84, v80
v_mov_b32 v85, v81
v_mov_b32 v86, v82
v_mov_b32 v87, v83
v_permlane32_swap_b32 v80, v84
v_permlane32_swap_b32 v81, v85
v_permlane32_swap_b32 v82, v86
v_permlane32_swap_b32 v83, v87
v_mul_f32 v88, 0xbfb8aa3b, v80
v_mul_f32 v89, 0xbfb8aa3b, v81
v_mul_f32 v90, 0xbfb8aa3b, v82
v_mul_f32 v91, 0xbfb8aa3b, v83
v_exp_f32 v88, v88
v_exp_f32 v89, v89
v_exp_f32 v90, v90
v_exp_f32 v91, v91
v_add_f32 v88, 1.0, v88
v_add_f32 v89, 1.0, v89
v_add_f32 v90, 1.0, v90
v_add_f32 v91, 1.0, v91
v_rcp_f32 v88, v88
v_rcp_f32 v89, v89
v_rcp_f32 v90, v90
v_rcp_f32 v91, v91
v_mul_f32 v80, v80, v88
v_mul_f32 v81, v81, v89
v_mul_f32 v82, v82, v90
v_mul_f32 v83, v83, v91
v_cvt_pk_bf16_f32 v88, v80, v81
v_cvt_pk_bf16_f32 v89, v82, v83
v_lshlrev_b32 v80, 16, v88
v_and_b32 v81, 0xffff0000, v88
v_lshlrev_b32 v82, 16, v89
v_and_b32 v83, 0xffff0000, v89
v_pk_mul_f32 v[80:81], v[80:81], v[84:85]
v_pk_mul_f32 v[82:83], v[82:83], v[86:87]
v_cvt_pk_bf16_f32 v88, v80, v81
v_cvt_pk_bf16_f32 v89, v82, v83
v_bfe_u32 v6, v1, 2, 1
v_lshlrev_b32 v6, 7, v6
v_bfe_u32 v7, v1, 3, 2
v_lshl_add_u32 v6, v7, 5, v6
v_and_b32 v7, 3, v1
v_lshl_add_u32 v6, v7, 3, v6
v_add_u32 v6, 20480, v6
ds_write_b64 v6, v[88:89]
L_actj_48:
s_waitcnt lgkmcnt(0)
s_barrier
v_and_b32 v6, 1, v1
v_lshlrev_b32 v6, 7, v6
v_lshrrev_b32 v7, 5, v1
v_lshl_add_u32 v6, v7, 4, v6
v_add_u32 v6, 20480, v6
ds_read_b128 v[24:27], v6 offset:0
ds_read_b128 v[28:31], v6 offset:32
ds_read_b128 v[32:35], v6 offset:64
ds_read_b128 v[36:39], v6 offset:96
v_and_b32 v5, 31, v1
s_lshr_b32 s86, s79, 2
s_lshl_b32 s86, s86, 13
s_and_b32 s87, s79, 3
s_lshl_b32 s87, s87, 10
s_add_u32 s86, s86, s87
s_lshl_b32 s87, s72, 7
s_add_u32 s86, s86, s87
s_add_u32 s86, s86, 14155776
v_lshrrev_b32 v6, 5, v1
v_lshlrev_b32 v6, 12, v6
v_lshl_add_u32 v6, v5, 2, v6
v_add_u32 v6, s86, v6
s_waitcnt lgkmcnt(0)
v_mfma_f32_32x32x16_bf16 v[40:55], v[24:27], v[8:11], 0
v_mfma_f32_32x32x16_bf16 v[56:71], v[28:31], v[12:15], 0
v_mfma_f32_32x32x16_bf16 v[40:55], v[32:35], v[16:19], v[40:55]
v_mfma_f32_32x32x16_bf16 v[56:71], v[36:39], v[20:23], v[56:71]
s_nop 11
v_pk_add_f32 v[40:41], v[40:41], v[56:57]
s_nop 1
v_permlane32_swap_b32 v40, v41
s_mov_b32 s88, 0x7fc00000
v_mov_b32 v5, s88
v_cmp_eq_u32 vcc, -1, v40
s_nop 1
v_cndmask_b32 v40, v40, v5, vcc
buffer_store_dword v40, v6, s[44:47], 0 offen sc1
s_lshr_b32 s86, s78, 3
s_cmp_ge_u32 s86, 8
s_cbranch_scc1 L_fin
s_and_b32 s87, s78, 7
s_lshl_b32 s87, s87, 3
s_add_u32 s86, s86, s87
s_lshr_b32 s80, s86, 5
s_and_b32 s81, s86, 31
v_lshrrev_b32 v6, 3, v1
v_cmp_gt_u32 s[94:95], 7, v6
s_nop 1
v_cndmask_b32 v6, 0, v6, s[94:95]
s_mul_i32 s86, s72, 7
v_add_u32 v6, s86, v6
v_lshlrev_b32 v6, 13, v6
s_lshl_b32 s86, s80, 12
s_lshl_b32 s87, s81, 7
s_add_u32 s86, s86, s87
s_add_u32 s86, s86, 14155776
v_and_b32 v7, 7, v1
v_lshl_add_u32 v6, v7, 4, v6
v_add_u32 v6, s86, v6
s_mov_b32 s90, 0
L_ypoll_51:
buffer_load_dwordx4 v[8:11], v6, s[44:47], 0 offen sc1
s_waitcnt vmcnt(0)
v_max3_u32 v7, v8, v9, v10
v_max_u32 v7, v7, v11
v_cmp_eq_u32 vcc, -1, v7
s_nop 1
s_cbranch_vccz L_yok_52
s_add_u32 s90, s90, 1
s_cmp_gt_u32 s90, 200000
s_cbranch_scc1 L_yok_52
s_branch L_ypoll_51
L_yok_52:
v_cndmask_b32 v8, 0, v8, s[94:95]
v_cndmask_b32 v9, 0, v9, s[94:95]
v_cndmask_b32 v10, 0, v10, s[94:95]
v_cndmask_b32 v11, 0, v11, s[94:95]
v_add_f32_dpp v8, v8, v8 row_ror:8 row_mask:0xf bank_mask:0xf
v_add_f32_dpp v9, v9, v9 row_ror:8 row_mask:0xf bank_mask:0xf
v_add_f32_dpp v10, v10, v10 row_ror:8 row_mask:0xf bank_mask:0xf
v_add_f32_dpp v11, v11, v11 row_ror:8 row_mask:0xf bank_mask:0xf
v_mov_b32 v16, v8
s_nop 1
v_permlane16_swap_b32 v8, v16
v_add_f32 v8, v8, v16
v_mov_b32 v17, v9
s_nop 1
v_permlane16_swap_b32 v9, v17
v_add_f32 v9, v9, v17
v_mov_b32 v18, v10
s_nop 1
v_permlane16_swap_b32 v10, v18
v_add_f32 v10, v10, v18
v_mov_b32 v19, v11
s_nop 1
v_permlane16_swap_b32 v11, v19
v_add_f32 v11, v11, v19
v_mov_b32 v16, v8
s_nop 1
v_permlane32_swap_b32 v8, v16
v_add_f32 v8, v8, v16
v_mov_b32 v17, v9
s_nop 1
v_permlane32_swap_b32 v9, v17
v_add_f32 v9, v9, v17
v_mov_b32 v18, v10
s_nop 1
v_permlane32_swap_b32 v10, v18
v_add_f32 v10, v10, v18
v_mov_b32 v19, v11
s_nop 1
v_permlane32_swap_b32 v11, v19
v_add_f32 v11, v11, v19
s_lshl_b32 s86, s72, 7
s_add_u32 s86, s86, 24576
v_and_b32 v6, 7, v1
v_lshl_add_u32 v6, v6, 4, s86
ds_write_b128 v6, v[8:11]
s_waitcnt lgkmcnt(0)
s_barrier
s_cmp_lg_u32 s72, 1
s_cbranch_scc1 L_fin
v_and_b32 v6, 31, v1
v_lshlrev_b32 v6, 2, v6
v_add_u32 v6, 24576, v6
ds_read_b32 v8, v6 offset:0
ds_read_b32 v9, v6 offset:128
ds_read_b32 v10, v6 offset:256
ds_read_b32 v11, v6 offset:384
ds_read_b32 v12, v6 offset:512
ds_read_b32 v13, v6 offset:640
ds_read_b32 v14, v6 offset:768
ds_read_b32 v15, v6 offset:896
s_waitcnt lgkmcnt(0)
v_add_f32 v8, v8, v12
v_add_f32 v9, v9, v13
v_add_f32 v10, v10, v14
v_add_f32 v11, v11, v15
v_add_f32 v8, v8, v10
v_add_f32 v9, v9, v11
v_add_f32 v8, v8, v9
v_cvt_pk_bf16_f32 v9, v8, v8
v_lshlrev_b32 v8, 16, v9
v_mul_f32 v8, v8, v110
v_cvt_pk_bf16_f32 v9, v8, v8
v_lshlrev_b32 v8, 16, v9
v_add_f32 v8, v8, v112
v_cvt_pk_bf16_f32 v9, v8, v8
v_lshlrev_b32 v8, 16, v9
v_add_f32 v8, v8, v113
v_cvt_pk_bf16_f32 v8, v8, v8
v_cmp_gt_u32 vcc, 32, v1
s_nop 1
s_and_saveexec_b64 s[96:97], vcc
buffer_store_short v8, v114, s[48:51], 0 offen sc1
s_mov_b64 exec, s[96:97]
L_fin:
L_exit:
s_endpgm
L_code_end:
.section .rodata,"a"
.p2align 6
.amdhsa_kernel sequential_preLN__sliding_block__moe_arch_mod__prompt_kernel
.amdhsa_next_free_vgpr 256
.amdhsa_next_free_sgpr 102
.amdhsa_accum_offset 256
.amdhsa_group_segment_fixed_size 0
.amdhsa_kernarg_size 88
.amdhsa_user_sgpr_count 2
.amdhsa_user_sgpr_kernarg_segment_ptr 1
.amdhsa_system_sgpr_workgroup_id_x 1
.end_amdhsa_kernel
```
